```python
import torch

def _softmax(x, axis=-1):
    return torch.softmax(x, dim=axis)
def _gelu(x):
    return torch.nn.functional.gelu(x, approximate="tanh")
def _silu(x):
    return torch.nn.functional.silu(x)
def _sigmoid(x):
    return torch.sigmoid(x)
def _layernorm(x, axis=-1, eps=1e-5):
    m = x.mean(dim=axis, keepdim=True)
    v = x.var(dim=axis, keepdim=True, unbiased=False)
    return (x - m) / torch.sqrt(v + eps)
def _scatter_add(tgt, idx, src, axis=0):
    return tgt.clone().index_add_(axis, idx, src)
def _segment_sum(src, seg, n):
    out = torch.zeros((n,) + src.shape[1:], dtype=src.dtype)
    return out.index_add_(0, seg, src)
def _pad(x, pw):
    flat = tuple(v for pair in reversed(pw) for v in pair)
    return torch.nn.functional.pad(x, flat)

kernel_name = 'concat_heads__mha_block_cached__gqa_block_cached__decode'

def setup_inputs():

    _w = (lambda a: (lambda t: t.to(torch.bfloat16) if t.is_floating_point() else t)(torch.as_tensor(a)))
    def _A_setup():
        B, Sq, D = 8, 1, 512
        H, Sk, Dh = 32, 4096, 128
        return {
            "x": _w((lambda *s: torch.randn(*s, dtype=torch.bfloat16) * 0.8)(B, Sq, D)),
            "k_cache": _w((lambda *s: torch.randn(*s, dtype=torch.bfloat16) * 0.8)(B, H, Sk, Dh)),
            "v_cache": _w((lambda *s: torch.randn(*s, dtype=torch.bfloat16) * 0.05)(B, H, Sk, Dh)),
            "wq": _w((lambda *s: torch.randn(*s, dtype=torch.bfloat16) * 0.8)(D, H * Dh) * (D ** -0.5)),
            "wo": _w((lambda *s: torch.randn(*s, dtype=torch.bfloat16) * 0.05)(H * Dh, D) * ((H * Dh) ** -0.5)),
        }
    _A_in = _A_setup()

    def _B_setup():
        B, Sq, D = 8, 1, 512
        Hq, Hkv, Sk, Dh = 32, 8, 4096, 128
        assert Hq % Hkv == 0, (Hq, Hkv)
        return {
            "x": _w((lambda *s: torch.randn(*s, dtype=torch.bfloat16) * 0.8)(B, Sq, D)),
            "k_cache": _w((lambda *s: torch.randn(*s, dtype=torch.bfloat16) * 0.8)(B, Hkv, Sk, Dh)),
            "v_cache": _w((lambda *s: torch.randn(*s, dtype=torch.bfloat16) * 0.05)(B, Hkv, Sk, Dh)),
            "wq": _w((lambda *s: torch.randn(*s, dtype=torch.bfloat16) * 0.8)(D, Hq * Dh) * (D ** -0.5)),
            "wo": _w((lambda *s: torch.randn(*s, dtype=torch.bfloat16) * 0.05)(Hq * Dh, D) * ((Hq * Dh) ** -0.5)),
        }
    _B_in = _B_setup()

    return {
        "A_x": _A_in["x"],
        "A_k_cache": _A_in["k_cache"],
        "A_v_cache": _A_in["v_cache"],
        "A_wq": _A_in["wq"],
        "A_wo": _A_in["wo"],
        "B_x": _B_in["x"],
        "B_k_cache": _B_in["k_cache"],
        "B_v_cache": _B_in["v_cache"],
        "B_wq": _B_in["wq"],
        "B_wo": _B_in["wo"],
    }

def reference(A_x, A_k_cache, A_v_cache, A_wq, A_wo, B_x, B_k_cache, B_v_cache, B_wq, B_wo):
    def _A_ref(x, k_cache, v_cache, wq, wo):
        B, Sq, D = x.shape
        H, Dh = 32, 128
        q = (lambda x, *d: x.permute(*d))((x @ wq).reshape(B, Sq, H, Dh), 0, 2, 1, 3)
        scores = torch.einsum("bhqd,bhkd->bhqk", q, k_cache) * (Dh ** -0.5)
        p = _softmax(scores, axis=-1)
        o = torch.einsum("bhqk,bhkd->bhqd", p, v_cache)
        return (lambda x, *d: x.permute(*d))(o, 0, 2, 1, 3).reshape(B, Sq, H * Dh) @ wo

    def _B_ref(x, k_cache, v_cache, wq, wo):
        B, Sq, D = x.shape
        Hq, Dh = 32, 128
        Hkv = k_cache.shape[1]
        rep = Hq // Hkv
        q = (lambda x, *d: x.permute(*d))((x @ wq).reshape(B, Sq, Hq, Dh), 0, 2, 1, 3)
        k = (lambda x, n, axis: torch.repeat_interleave(x, n, dim=axis))(k_cache, rep, axis=1)
        v = (lambda x, n, axis: torch.repeat_interleave(x, n, dim=axis))(v_cache, rep, axis=1)
        scores = torch.einsum("bhqd,bhkd->bhqk", q, k) * (Dh ** -0.5)
        p = _softmax(scores, axis=-1)
        o = torch.einsum("bhqk,bhkd->bhqd", p, v)
        return (lambda x, *d: x.permute(*d))(o, 0, 2, 1, 3).reshape(B, Sq, Hq * Dh) @ wo

    a = _A_ref(A_x, A_k_cache, A_v_cache, A_wq, A_wo)
    b = _B_ref(B_x, B_k_cache, B_v_cache, B_wq, B_wo)
    return torch.concatenate([a, b], axis=-1)
```

```asm
; @launch grid=(256,1,1) block=(512,1,1) lds=147456
.amdgcn_target "amdgcn-amd-amdhsa--gfx950"
.text
.globl concat_heads__mha_block_cached__gqa_block_cached__decode_kernel
.p2align 8
.type concat_heads__mha_block_cached__gqa_block_cached__decode_kernel,@function
concat_heads__mha_block_cached__gqa_block_cached__decode_kernel:
    s_cmp_ge_u32 s2, 256
    s_cbranch_scc1 DONE
    s_load_dwordx16 s[16:31], s[0:1], 0
    s_load_dwordx8 s[32:39], s[0:1], 64
    s_load_dwordx2 s[40:41], s[0:1], 96
    s_and_b32 s3, s2, 7
    s_lshr_b32 s4, s2, 5
    s_bfe_u32 s5, s2, 0x20003
    s_lshl_b32 s6, s3, 2
    s_add_u32 s6, s6, s5
    s_lshl_b32 s7, s4, 5
    s_add_u32 s7, s7, s6
    v_lshrrev_b32 v1, 6, v0
    v_and_b32 v0, 63, v0
    v_readfirstlane_b32 s8, v1
    s_lshl_b32 s14, s4, 3
    s_add_u32 s14, s14, s3
    s_lshl_b32 s14, s14, 20
    s_lshl_b32 s15, s5, 18
    s_add_u32 s14, s14, s15
    s_cmp_ge_u32 s8, 4
    s_waitcnt lgkmcnt(0)
    s_cbranch_scc1 HELPER
    s_lshl_b32 s10, s7, 20
    s_add_u32 s56, s18, s10
    s_addc_u32 s57, s19, 0
    s_add_u32 s58, s20, s10
    s_addc_u32 s59, s21, 0
    s_mov_b64 s[44:45], s[56:57]
    s_mov_b64 s[48:49], s[58:59]
    s_mov_b32 s46, 0x100000
    s_mov_b32 s50, 0x100000
    s_mov_b32 s47, 0x20000
    s_mov_b32 s51, 0x20000
    s_lshl_b32 s10, s8, 12
    v_lshlrev_b32 v2, 4, v0
    v_add_u32 v2, s10, v2
    s_mov_b32 s64, 0
    s_mov_b32 s65, 16384
    s_mov_b32 s66, 32768
    s_mov_b32 s67, 49152
    buffer_load_dwordx4 v[108:111], v2, s[44:47], s64 offen nt
    buffer_load_dwordx4 v[112:115], v2, s[44:47], s64 offen offset:1024 nt
    buffer_load_dwordx4 v[116:119], v2, s[44:47], s64 offen offset:2048 nt
    buffer_load_dwordx4 v[120:123], v2, s[44:47], s64 offen offset:3072 nt
    buffer_load_dwordx4 v[124:127], v2, s[48:51], s64 offen nt
    buffer_load_dwordx4 v[128:131], v2, s[48:51], s64 offen offset:1024 nt
    s_add_u32 s60, s28, s14
    s_addc_u32 s61, s29, 0
    s_add_u32 s62, s30, s14
    s_addc_u32 s63, s31, 0
    s_mov_b32 s9, 1
    v_and_b32 v7, 3, v0
    v_mov_b32 v3, 0
    v_mov_b32 v4, 0
    v_cmp_eq_u32 vcc, 0, v7
    v_mov_b32 v8, 0xffff
    s_nop 0
    v_cndmask_b32 v3, v3, v8, vcc
    v_cmp_eq_u32 vcc, 1, v7
    v_mov_b32 v8, 0xffff0000
    s_nop 0
    v_cndmask_b32 v3, v3, v8, vcc
    v_cmp_eq_u32 vcc, 2, v7
    v_mov_b32 v8, 0xffff
    s_nop 0
    v_cndmask_b32 v4, v4, v8, vcc
    v_cmp_eq_u32 vcc, 3, v7
    v_mov_b32 v8, 0xffff0000
    s_nop 0
    v_cndmask_b32 v4, v4, v8, vcc
    v_mov_b32 v5, 0x3e0293ee
    v_lshrrev_b32 v6, 4, v0
    v_lshlrev_b32 v6, 4, v6
    v_mov_b32 v11, 0xff800000
    v_mov_b32 v12, 0xff800000
    v_mov_b32 v14, 0xff800000
    v_mov_b32 v15, 0xff800000
    v_mov_b32 v13, 0
    v_mov_b32 v16, 0
    v_mov_b32 v60, 0
    v_mov_b32 v68, 0
    v_mov_b32 v61, 0
    v_mov_b32 v69, 0
    v_mov_b32 v62, 0
    v_mov_b32 v70, 0
    v_mov_b32 v63, 0
    v_mov_b32 v71, 0
    v_mov_b32 v64, 0
    v_mov_b32 v72, 0
    v_mov_b32 v65, 0
    v_mov_b32 v73, 0
    v_mov_b32 v66, 0
    v_mov_b32 v74, 0
    v_mov_b32 v67, 0
    v_mov_b32 v75, 0
    v_lshlrev_b32 v7, 2, v0
    s_mov_b64 exec, 0xffff
    ds_write_b32 v7, v13 offset:4160
    s_mov_b64 exec, -1
    s_barrier
    s_waitcnt vmcnt(5)
    buffer_load_dwordx4 v[132:135], v2, s[48:51], s64 offen offset:2048 nt
    s_waitcnt vmcnt(5)
    buffer_load_dwordx4 v[136:139], v2, s[48:51], s64 offen offset:3072 nt
    s_waitcnt vmcnt(5)
    buffer_load_dwordx4 v[140:143], v2, s[44:47], s65 offen nt
    s_waitcnt vmcnt(5)
    buffer_load_dwordx4 v[144:147], v2, s[44:47], s65 offen offset:1024 nt
    s_waitcnt vmcnt(5)
    buffer_load_dwordx4 v[148:151], v2, s[44:47], s65 offen offset:2048 nt
    s_waitcnt vmcnt(5)
    buffer_load_dwordx4 v[152:155], v2, s[44:47], s65 offen offset:3072 nt
    s_waitcnt vmcnt(5)
    buffer_load_dwordx4 v[156:159], v2, s[48:51], s65 offen nt
    s_waitcnt vmcnt(5)
    buffer_load_dwordx4 v[160:163], v2, s[48:51], s65 offen offset:1024 nt
    s_waitcnt vmcnt(5)
    buffer_load_dwordx4 v[164:167], v2, s[48:51], s65 offen offset:2048 nt
    s_waitcnt vmcnt(5)
    buffer_load_dwordx4 v[168:171], v2, s[48:51], s65 offen offset:3072 nt
    s_waitcnt vmcnt(5)
    buffer_load_dwordx4 v[172:175], v2, s[44:47], s66 offen nt
    s_waitcnt vmcnt(5)
    buffer_load_dwordx4 v[176:179], v2, s[44:47], s66 offen offset:1024 nt
    s_waitcnt vmcnt(5)
    buffer_load_dwordx4 v[180:183], v2, s[44:47], s66 offen offset:2048 nt
    s_waitcnt vmcnt(5)
    buffer_load_dwordx4 v[184:187], v2, s[44:47], s66 offen offset:3072 nt
    s_waitcnt vmcnt(5)
    buffer_load_dwordx4 v[188:191], v2, s[48:51], s66 offen nt
    s_waitcnt vmcnt(5)
    buffer_load_dwordx4 v[192:195], v2, s[48:51], s66 offen offset:1024 nt
    s_waitcnt vmcnt(5)
    buffer_load_dwordx4 v[196:199], v2, s[48:51], s66 offen offset:2048 nt
    s_waitcnt vmcnt(5)
    buffer_load_dwordx4 v[200:203], v2, s[48:51], s66 offen offset:3072 nt
    s_waitcnt vmcnt(5)
    buffer_load_dwordx4 v[204:207], v2, s[44:47], s67 offen nt
    s_waitcnt vmcnt(5)
    buffer_load_dwordx4 v[208:211], v2, s[44:47], s67 offen offset:1024 nt
    s_waitcnt vmcnt(5)
    buffer_load_dwordx4 v[212:215], v2, s[44:47], s67 offen offset:2048 nt
    s_waitcnt vmcnt(5)
    buffer_load_dwordx4 v[216:219], v2, s[44:47], s67 offen offset:3072 nt
    s_waitcnt vmcnt(5)
    buffer_load_dwordx4 v[220:223], v2, s[48:51], s67 offen nt
    s_waitcnt vmcnt(5)
    buffer_load_dwordx4 v[224:227], v2, s[48:51], s67 offen offset:1024 nt
    s_waitcnt vmcnt(5)
    buffer_load_dwordx4 v[228:231], v2, s[48:51], s67 offen offset:2048 nt
    s_waitcnt vmcnt(5)
    buffer_load_dwordx4 v[232:235], v2, s[48:51], s67 offen offset:3072 nt
    s_waitcnt lgkmcnt(0)
    s_barrier
    v_and_b32 v9, 15, v0
    v_lshlrev_b32 v9, 5, v9
    ds_read_b128 v[76:79], v9 offset:0
    ds_read_b128 v[80:83], v9 offset:16
    ds_read_b128 v[84:87], v9 offset:512
    ds_read_b128 v[88:91], v9 offset:528
    ds_read_b128 v[92:95], v9 offset:1024
    ds_read_b128 v[96:99], v9 offset:1040
    ds_read_b128 v[100:103], v9 offset:1536
    ds_read_b128 v[104:107], v9 offset:1552
    s_waitcnt lgkmcnt(0)
    v_add_f32 v76, v76, v84
    v_add_f32 v92, v92, v100
    v_add_f32 v77, v77, v85
    v_add_f32 v93, v93, v101
    v_add_f32 v78, v78, v86
    v_add_f32 v94, v94, v102
    v_add_f32 v79, v79, v87
    v_add_f32 v95, v95, v103
    v_add_f32 v80, v80, v88
    v_add_f32 v96, v96, v104
    v_add_f32 v81, v81, v89
    v_add_f32 v97, v97, v105
    v_add_f32 v82, v82, v90
    v_add_f32 v98, v98, v106
    v_add_f32 v83, v83, v91
    v_add_f32 v99, v99, v107
    v_add_f32 v76, v76, v92
    v_add_f32 v77, v77, v93
    v_add_f32 v78, v78, v94
    v_add_f32 v79, v79, v95
    v_add_f32 v80, v80, v96
    v_add_f32 v81, v81, v97
    v_add_f32 v82, v82, v98
    v_add_f32 v83, v83, v99
    v_cvt_pk_bf16_f32 v40, v76, v77
    v_cvt_pk_bf16_f32 v41, v78, v79
    v_cvt_pk_bf16_f32 v42, v80, v81
    v_cvt_pk_bf16_f32 v43, v82, v83
LOOP_A:
    v_mov_b32 v9, 0
    v_mov_b32 v8, s9
    s_mov_b64 exec, 1
    ds_max_u32 v9, v8 offset:4172
    s_mov_b64 exec, -1
    ds_read_b32 v10, v9 offset:4168
    s_sub_u32 s10, s9, 7
    s_cmp_lt_u32 s10, 4
    s_cselect_b64 s[44:45], s[60:61], s[56:57]
    s_cselect_b64 s[48:49], s[62:63], s[58:59]
    s_mov_b32 s11, 0x100000
    s_cselect_b32 s46, 0x40000, s11
    s_mov_b32 s50, s46
    s_cselect_b32 s10, s10, s9
    s_sub_u32 s11, s9, 4
    s_cmp_ge_u32 s9, 11
    s_cselect_b32 s10, s11, s10
    s_lshl_b32 s64, s10, 16
    s_add_u32 s65, s64, 16384
    s_add_u32 s66, s64, 32768
    s_add_u32 s67, s64, 49152
    s_add_u32 s9, s9, 1
    v_dot2_f32_bf16 v17, v108, v40, 0
    v_dot2_f32_bf16 v18, v112, v40, 0
    v_dot2_f32_bf16 v19, v116, v40, 0
    v_dot2_f32_bf16 v20, v120, v40, 0
    v_dot2_f32_bf16 v17, v109, v41, v17
    v_dot2_f32_bf16 v18, v113, v41, v18
    v_dot2_f32_bf16 v19, v117, v41, v19
    v_dot2_f32_bf16 v20, v121, v41, v20
    v_dot2_f32_bf16 v17, v110, v42, v17
    v_dot2_f32_bf16 v18, v114, v42, v18
    v_dot2_f32_bf16 v19, v118, v42, v19
    v_dot2_f32_bf16 v20, v122, v42, v20
    v_dot2_f32_bf16 v17, v111, v43, v17
    v_dot2_f32_bf16 v18, v115, v43, v18
    v_dot2_f32_bf16 v19, v119, v43, v19
    v_dot2_f32_bf16 v20, v123, v43, v20
    s_waitcnt vmcnt(5)
    buffer_load_dwordx4 v[108:111], v2, s[44:47], s64 offen nt
    s_nop 0
    v_add_f32_dpp v17, v17, v17 row_ror:8 row_mask:0xf bank_mask:0x3
    v_add_f32_dpp v18, v18, v18 row_ror:8 row_mask:0xf bank_mask:0x3
    v_add_f32_dpp v17, v19, v19 row_ror:8 row_mask:0xf bank_mask:0xc
    v_add_f32_dpp v18, v20, v20 row_ror:8 row_mask:0xf bank_mask:0xc
    s_nop 1
    s_waitcnt vmcnt(5)
    buffer_load_dwordx4 v[112:115], v2, s[44:47], s64 offen offset:1024 nt
    v_add_f32_dpp v21, v17, v17 row_half_mirror row_mask:0xf bank_mask:0x5
    v_add_f32_dpp v21, v18, v18 row_half_mirror row_mask:0xf bank_mask:0xa
    s_nop 1
    v_add_f32_dpp v21, v21, v21 quad_perm:[1,0,3,2] row_mask:0xf bank_mask:0xf
    s_nop 1
    v_add_f32_dpp v21, v21, v21 quad_perm:[2,3,0,1] row_mask:0xf bank_mask:0xf
    v_cmp_gt_f32 vcc, v21, v11
    s_cbranch_vccnz SLOWA_1
BACKA_2:
    v_fma_f32 v25, v21, v5, -v12
    v_exp_f32 v25, v25
    s_waitcnt vmcnt(5)
    buffer_load_dwordx4 v[116:119], v2, s[44:47], s64 offen offset:2048 nt
    v_add_f32 v13, v13, v25
    v_cvt_pk_bf16_f32 v26, v25, v25
    s_waitcnt vmcnt(5)
    buffer_load_dwordx4 v[120:123], v2, s[44:47], s64 offen offset:3072 nt
    v_and_b32_dpp v30, v26, v3 row_newbcast:0 row_mask:0xf bank_mask:0xf
    v_and_b32_dpp v31, v26, v4 row_newbcast:0 row_mask:0xf bank_mask:0xf
    v_and_b32_dpp v32, v26, v3 row_newbcast:4 row_mask:0xf bank_mask:0xf
    v_and_b32_dpp v33, v26, v4 row_newbcast:4 row_mask:0xf bank_mask:0xf
    v_and_b32_dpp v34, v26, v3 row_newbcast:8 row_mask:0xf bank_mask:0xf
    v_and_b32_dpp v35, v26, v4 row_newbcast:8 row_mask:0xf bank_mask:0xf
    v_and_b32_dpp v36, v26, v3 row_newbcast:12 row_mask:0xf bank_mask:0xf
    v_and_b32_dpp v37, v26, v4 row_newbcast:12 row_mask:0xf bank_mask:0xf
    s_nop 0
    v_mfma_f32_16x16x16_bf16 v[60:63], v[30:31], v[124:125], v[60:63]
    v_mfma_f32_16x16x16_bf16 v[64:67], v[30:31], v[126:127], v[64:67]
    s_waitcnt vmcnt(5)
    buffer_load_dwordx4 v[124:127], v2, s[48:51], s64 offen nt
    v_mfma_f32_16x16x16_bf16 v[60:63], v[32:33], v[128:129], v[60:63]
    v_mfma_f32_16x16x16_bf16 v[64:67], v[32:33], v[130:131], v[64:67]
    s_waitcnt vmcnt(5)
    buffer_load_dwordx4 v[128:131], v2, s[48:51], s64 offen offset:1024 nt
    v_mfma_f32_16x16x16_bf16 v[60:63], v[34:35], v[132:133], v[60:63]
    v_mfma_f32_16x16x16_bf16 v[64:67], v[34:35], v[134:135], v[64:67]
    s_waitcnt vmcnt(5)
    buffer_load_dwordx4 v[132:135], v2, s[48:51], s64 offen offset:2048 nt
    v_mfma_f32_16x16x16_bf16 v[60:63], v[36:37], v[136:137], v[60:63]
    v_mfma_f32_16x16x16_bf16 v[64:67], v[36:37], v[138:139], v[64:67]
    s_waitcnt vmcnt(5)
    buffer_load_dwordx4 v[136:139], v2, s[48:51], s64 offen offset:3072 nt
    v_dot2_f32_bf16 v17, v140, v40, 0
    v_dot2_f32_bf16 v18, v144, v40, 0
    v_dot2_f32_bf16 v19, v148, v40, 0
    v_dot2_f32_bf16 v20, v152, v40, 0
    v_dot2_f32_bf16 v17, v141, v41, v17
    v_dot2_f32_bf16 v18, v145, v41, v18
    v_dot2_f32_bf16 v19, v149, v41, v19
    v_dot2_f32_bf16 v20, v153, v41, v20
    v_dot2_f32_bf16 v17, v142, v42, v17
    v_dot2_f32_bf16 v18, v146, v42, v18
    v_dot2_f32_bf16 v19, v150, v42, v19
    v_dot2_f32_bf16 v20, v154, v42, v20
    v_dot2_f32_bf16 v17, v143, v43, v17
    v_dot2_f32_bf16 v18, v147, v43, v18
    v_dot2_f32_bf16 v19, v151, v43, v19
    v_dot2_f32_bf16 v20, v155, v43, v20
    s_waitcnt vmcnt(5)
    buffer_load_dwordx4 v[140:143], v2, s[44:47], s65 offen nt
    s_nop 0
    v_add_f32_dpp v17, v17, v17 row_ror:8 row_mask:0xf bank_mask:0x3
    v_add_f32_dpp v18, v18, v18 row_ror:8 row_mask:0xf bank_mask:0x3
    v_add_f32_dpp v17, v19, v19 row_ror:8 row_mask:0xf bank_mask:0xc
    v_add_f32_dpp v18, v20, v20 row_ror:8 row_mask:0xf bank_mask:0xc
    s_nop 1
    s_waitcnt vmcnt(5)
    buffer_load_dwordx4 v[144:147], v2, s[44:47], s65 offen offset:1024 nt
    v_add_f32_dpp v21, v17, v17 row_half_mirror row_mask:0xf bank_mask:0x5
    v_add_f32_dpp v21, v18, v18 row_half_mirror row_mask:0xf bank_mask:0xa
    s_nop 1
    v_add_f32_dpp v21, v21, v21 quad_perm:[1,0,3,2] row_mask:0xf bank_mask:0xf
    s_nop 1
    v_add_f32_dpp v21, v21, v21 quad_perm:[2,3,0,1] row_mask:0xf bank_mask:0xf
    v_cmp_gt_f32 vcc, v21, v11
    s_cbranch_vccnz SLOWA_3
BACKA_4:
    v_fma_f32 v25, v21, v5, -v12
    v_exp_f32 v25, v25
    s_waitcnt vmcnt(5)
    buffer_load_dwordx4 v[148:151], v2, s[44:47], s65 offen offset:2048 nt
    v_add_f32 v13, v13, v25
    v_cvt_pk_bf16_f32 v26, v25, v25
    s_waitcnt vmcnt(5)
    buffer_load_dwordx4 v[152:155], v2, s[44:47], s65 offen offset:3072 nt
    v_and_b32_dpp v30, v26, v3 row_newbcast:0 row_mask:0xf bank_mask:0xf
    v_and_b32_dpp v31, v26, v4 row_newbcast:0 row_mask:0xf bank_mask:0xf
    v_and_b32_dpp v32, v26, v3 row_newbcast:4 row_mask:0xf bank_mask:0xf
    v_and_b32_dpp v33, v26, v4 row_newbcast:4 row_mask:0xf bank_mask:0xf
    v_and_b32_dpp v34, v26, v3 row_newbcast:8 row_mask:0xf bank_mask:0xf
    v_and_b32_dpp v35, v26, v4 row_newbcast:8 row_mask:0xf bank_mask:0xf
    v_and_b32_dpp v36, v26, v3 row_newbcast:12 row_mask:0xf bank_mask:0xf
    v_and_b32_dpp v37, v26, v4 row_newbcast:12 row_mask:0xf bank_mask:0xf
    s_nop 0
    v_mfma_f32_16x16x16_bf16 v[60:63], v[30:31], v[156:157], v[60:63]
    v_mfma_f32_16x16x16_bf16 v[64:67], v[30:31], v[158:159], v[64:67]
    s_waitcnt vmcnt(5)
    buffer_load_dwordx4 v[156:159], v2, s[48:51], s65 offen nt
    v_mfma_f32_16x16x16_bf16 v[60:63], v[32:33], v[160:161], v[60:63]
    v_mfma_f32_16x16x16_bf16 v[64:67], v[32:33], v[162:163], v[64:67]
    s_waitcnt vmcnt(5)
    buffer_load_dwordx4 v[160:163], v2, s[48:51], s65 offen offset:1024 nt
    v_mfma_f32_16x16x16_bf16 v[60:63], v[34:35], v[164:165], v[60:63]
    v_mfma_f32_16x16x16_bf16 v[64:67], v[34:35], v[166:167], v[64:67]
    s_waitcnt vmcnt(5)
    buffer_load_dwordx4 v[164:167], v2, s[48:51], s65 offen offset:2048 nt
    v_mfma_f32_16x16x16_bf16 v[60:63], v[36:37], v[168:169], v[60:63]
    v_mfma_f32_16x16x16_bf16 v[64:67], v[36:37], v[170:171], v[64:67]
    s_waitcnt vmcnt(5)
    buffer_load_dwordx4 v[168:171], v2, s[48:51], s65 offen offset:3072 nt
    v_dot2_f32_bf16 v17, v172, v40, 0
    v_dot2_f32_bf16 v18, v176, v40, 0
    v_dot2_f32_bf16 v19, v180, v40, 0
    v_dot2_f32_bf16 v20, v184, v40, 0
    v_dot2_f32_bf16 v17, v173, v41, v17
    v_dot2_f32_bf16 v18, v177, v41, v18
    v_dot2_f32_bf16 v19, v181, v41, v19
    v_dot2_f32_bf16 v20, v185, v41, v20
    v_dot2_f32_bf16 v17, v174, v42, v17
    v_dot2_f32_bf16 v18, v178, v42, v18
    v_dot2_f32_bf16 v19, v182, v42, v19
    v_dot2_f32_bf16 v20, v186, v42, v20
    v_dot2_f32_bf16 v17, v175, v43, v17
    v_dot2_f32_bf16 v18, v179, v43, v18
    v_dot2_f32_bf16 v19, v183, v43, v19
    v_dot2_f32_bf16 v20, v187, v43, v20
    s_waitcnt vmcnt(5)
    buffer_load_dwordx4 v[172:175], v2, s[44:47], s66 offen nt
    s_nop 0
    v_add_f32_dpp v17, v17, v17 row_ror:8 row_mask:0xf bank_mask:0x3
    v_add_f32_dpp v18, v18, v18 row_ror:8 row_mask:0xf bank_mask:0x3
    v_add_f32_dpp v17, v19, v19 row_ror:8 row_mask:0xf bank_mask:0xc
    v_add_f32_dpp v18, v20, v20 row_ror:8 row_mask:0xf bank_mask:0xc
    s_nop 1
    s_waitcnt vmcnt(5)
    buffer_load_dwordx4 v[176:179], v2, s[44:47], s66 offen offset:1024 nt
    v_add_f32_dpp v21, v17, v17 row_half_mirror row_mask:0xf bank_mask:0x5
    v_add_f32_dpp v21, v18, v18 row_half_mirror row_mask:0xf bank_mask:0xa
    s_nop 1
    v_add_f32_dpp v21, v21, v21 quad_perm:[1,0,3,2] row_mask:0xf bank_mask:0xf
    s_nop 1
    v_add_f32_dpp v21, v21, v21 quad_perm:[2,3,0,1] row_mask:0xf bank_mask:0xf
    v_cmp_gt_f32 vcc, v21, v11
    s_cbranch_vccnz SLOWA_5
BACKA_6:
    v_fma_f32 v25, v21, v5, -v12
    v_exp_f32 v25, v25
    s_waitcnt vmcnt(5)
    buffer_load_dwordx4 v[180:183], v2, s[44:47], s66 offen offset:2048 nt
    v_add_f32 v13, v13, v25
    v_cvt_pk_bf16_f32 v26, v25, v25
    s_waitcnt vmcnt(5)
    buffer_load_dwordx4 v[184:187], v2, s[44:47], s66 offen offset:3072 nt
    v_and_b32_dpp v30, v26, v3 row_newbcast:0 row_mask:0xf bank_mask:0xf
    v_and_b32_dpp v31, v26, v4 row_newbcast:0 row_mask:0xf bank_mask:0xf
    v_and_b32_dpp v32, v26, v3 row_newbcast:4 row_mask:0xf bank_mask:0xf
    v_and_b32_dpp v33, v26, v4 row_newbcast:4 row_mask:0xf bank_mask:0xf
    v_and_b32_dpp v34, v26, v3 row_newbcast:8 row_mask:0xf bank_mask:0xf
    v_and_b32_dpp v35, v26, v4 row_newbcast:8 row_mask:0xf bank_mask:0xf
    v_and_b32_dpp v36, v26, v3 row_newbcast:12 row_mask:0xf bank_mask:0xf
    v_and_b32_dpp v37, v26, v4 row_newbcast:12 row_mask:0xf bank_mask:0xf
    s_nop 0
    v_mfma_f32_16x16x16_bf16 v[60:63], v[30:31], v[188:189], v[60:63]
    v_mfma_f32_16x16x16_bf16 v[64:67], v[30:31], v[190:191], v[64:67]
    s_waitcnt vmcnt(5)
    buffer_load_dwordx4 v[188:191], v2, s[48:51], s66 offen nt
    v_mfma_f32_16x16x16_bf16 v[60:63], v[32:33], v[192:193], v[60:63]
    v_mfma_f32_16x16x16_bf16 v[64:67], v[32:33], v[194:195], v[64:67]
    s_waitcnt vmcnt(5)
    buffer_load_dwordx4 v[192:195], v2, s[48:51], s66 offen offset:1024 nt
    v_mfma_f32_16x16x16_bf16 v[60:63], v[34:35], v[196:197], v[60:63]
    v_mfma_f32_16x16x16_bf16 v[64:67], v[34:35], v[198:199], v[64:67]
    s_waitcnt vmcnt(5)
    buffer_load_dwordx4 v[196:199], v2, s[48:51], s66 offen offset:2048 nt
    v_mfma_f32_16x16x16_bf16 v[60:63], v[36:37], v[200:201], v[60:63]
    v_mfma_f32_16x16x16_bf16 v[64:67], v[36:37], v[202:203], v[64:67]
    s_waitcnt vmcnt(5)
    buffer_load_dwordx4 v[200:203], v2, s[48:51], s66 offen offset:3072 nt
    v_dot2_f32_bf16 v17, v204, v40, 0
    v_dot2_f32_bf16 v18, v208, v40, 0
    v_dot2_f32_bf16 v19, v212, v40, 0
    v_dot2_f32_bf16 v20, v216, v40, 0
    v_dot2_f32_bf16 v17, v205, v41, v17
    v_dot2_f32_bf16 v18, v209, v41, v18
    v_dot2_f32_bf16 v19, v213, v41, v19
    v_dot2_f32_bf16 v20, v217, v41, v20
    v_dot2_f32_bf16 v17, v206, v42, v17
    v_dot2_f32_bf16 v18, v210, v42, v18
    v_dot2_f32_bf16 v19, v214, v42, v19
    v_dot2_f32_bf16 v20, v218, v42, v20
    v_dot2_f32_bf16 v17, v207, v43, v17
    v_dot2_f32_bf16 v18, v211, v43, v18
    v_dot2_f32_bf16 v19, v215, v43, v19
    v_dot2_f32_bf16 v20, v219, v43, v20
    s_waitcnt vmcnt(5)
    buffer_load_dwordx4 v[204:207], v2, s[44:47], s67 offen nt
    s_nop 0
    v_add_f32_dpp v17, v17, v17 row_ror:8 row_mask:0xf bank_mask:0x3
    v_add_f32_dpp v18, v18, v18 row_ror:8 row_mask:0xf bank_mask:0x3
    v_add_f32_dpp v17, v19, v19 row_ror:8 row_mask:0xf bank_mask:0xc
    v_add_f32_dpp v18, v20, v20 row_ror:8 row_mask:0xf bank_mask:0xc
    s_nop 1
    s_waitcnt vmcnt(5)
    buffer_load_dwordx4 v[208:211], v2, s[44:47], s67 offen offset:1024 nt
    v_add_f32_dpp v21, v17, v17 row_half_mirror row_mask:0xf bank_mask:0x5
    v_add_f32_dpp v21, v18, v18 row_half_mirror row_mask:0xf bank_mask:0xa
    s_nop 1
    v_add_f32_dpp v21, v21, v21 quad_perm:[1,0,3,2] row_mask:0xf bank_mask:0xf
    s_nop 1
    v_add_f32_dpp v21, v21, v21 quad_perm:[2,3,0,1] row_mask:0xf bank_mask:0xf
    v_cmp_gt_f32 vcc, v21, v11
    s_cbranch_vccnz SLOWA_7
BACKA_8:
    v_fma_f32 v25, v21, v5, -v12
    v_exp_f32 v25, v25
    s_waitcnt vmcnt(5)
    buffer_load_dwordx4 v[212:215], v2, s[44:47], s67 offen offset:2048 nt
    v_add_f32 v13, v13, v25
    v_cvt_pk_bf16_f32 v26, v25, v25
    s_waitcnt vmcnt(5)
    buffer_load_dwordx4 v[216:219], v2, s[44:47], s67 offen offset:3072 nt
    v_and_b32_dpp v30, v26, v3 row_newbcast:0 row_mask:0xf bank_mask:0xf
    v_and_b32_dpp v31, v26, v4 row_newbcast:0 row_mask:0xf bank_mask:0xf
    v_and_b32_dpp v32, v26, v3 row_newbcast:4 row_mask:0xf bank_mask:0xf
    v_and_b32_dpp v33, v26, v4 row_newbcast:4 row_mask:0xf bank_mask:0xf
    v_and_b32_dpp v34, v26, v3 row_newbcast:8 row_mask:0xf bank_mask:0xf
    v_and_b32_dpp v35, v26, v4 row_newbcast:8 row_mask:0xf bank_mask:0xf
    v_and_b32_dpp v36, v26, v3 row_newbcast:12 row_mask:0xf bank_mask:0xf
    v_and_b32_dpp v37, v26, v4 row_newbcast:12 row_mask:0xf bank_mask:0xf
    s_nop 0
    v_mfma_f32_16x16x16_bf16 v[60:63], v[30:31], v[220:221], v[60:63]
    v_mfma_f32_16x16x16_bf16 v[64:67], v[30:31], v[222:223], v[64:67]
    s_waitcnt vmcnt(5)
    buffer_load_dwordx4 v[220:223], v2, s[48:51], s67 offen nt
    v_mfma_f32_16x16x16_bf16 v[60:63], v[32:33], v[224:225], v[60:63]
    v_mfma_f32_16x16x16_bf16 v[64:67], v[32:33], v[226:227], v[64:67]
    s_waitcnt vmcnt(5)
    buffer_load_dwordx4 v[224:227], v2, s[48:51], s67 offen offset:1024 nt
    v_mfma_f32_16x16x16_bf16 v[60:63], v[34:35], v[228:229], v[60:63]
    v_mfma_f32_16x16x16_bf16 v[64:67], v[34:35], v[230:231], v[64:67]
    s_waitcnt vmcnt(5)
    buffer_load_dwordx4 v[228:231], v2, s[48:51], s67 offen offset:2048 nt
    v_mfma_f32_16x16x16_bf16 v[60:63], v[36:37], v[232:233], v[60:63]
    v_mfma_f32_16x16x16_bf16 v[64:67], v[36:37], v[234:235], v[64:67]
    s_waitcnt vmcnt(5)
    buffer_load_dwordx4 v[232:235], v2, s[48:51], s67 offen offset:3072 nt
    s_cmp_eq_u32 s9, 8
    s_cbranch_scc1 PHASE_B
    s_cmp_eq_u32 s9, 19
    s_cbranch_scc1 LOOP_A2
    s_waitcnt lgkmcnt(0)
    v_readfirstlane_b32 s10, v10
    s_cmp_eq_u32 s10, 0
    s_cbranch_scc1 LOOP_A
    s_cmp_eq_u32 s10, 1
    s_cbranch_scc1 LOOP_LO
LOOP_HI:
    v_mov_b32 v9, 0
    v_mov_b32 v8, s9
    s_mov_b64 exec, 1
    ds_max_u32 v9, v8 offset:4172
    s_mov_b64 exec, -1
    s_sub_u32 s10, s9, 7
    s_cmp_lt_u32 s10, 4
    s_cselect_b64 s[44:45], s[60:61], s[56:57]
    s_cselect_b64 s[48:49], s[62:63], s[58:59]
    s_mov_b32 s11, 0x100000
    s_cselect_b32 s46, 0x40000, s11
    s_mov_b32 s50, s46
    s_cselect_b32 s10, s10, s9
    s_sub_u32 s11, s9, 4
    s_cmp_ge_u32 s9, 11
    s_cselect_b32 s10, s11, s10
    s_lshl_b32 s64, s10, 16
    s_add_u32 s65, s64, 16384
    s_add_u32 s66, s64, 32768
    s_add_u32 s67, s64, 49152
    s_add_u32 s9, s9, 1
    v_dot2_f32_bf16 v17, v108, v40, 0
    v_dot2_f32_bf16 v18, v112, v40, 0
    v_dot2_f32_bf16 v19, v116, v40, 0
    v_dot2_f32_bf16 v20, v120, v40, 0
    v_dot2_f32_bf16 v17, v109, v41, v17
    v_dot2_f32_bf16 v18, v113, v41, v18
    v_dot2_f32_bf16 v19, v117, v41, v19
    v_dot2_f32_bf16 v20, v121, v41, v20
    v_dot2_f32_bf16 v17, v110, v42, v17
    v_dot2_f32_bf16 v18, v114, v42, v18
    v_dot2_f32_bf16 v19, v118, v42, v19
    v_dot2_f32_bf16 v20, v122, v42, v20
    v_dot2_f32_bf16 v17, v111, v43, v17
    v_dot2_f32_bf16 v18, v115, v43, v18
    v_dot2_f32_bf16 v19, v119, v43, v19
    v_dot2_f32_bf16 v20, v123, v43, v20
    s_waitcnt vmcnt(7)
    buffer_load_dwordx4 v[108:111], v2, s[44:47], s64 offen nt
    s_nop 0
    v_add_f32_dpp v17, v17, v17 row_ror:8 row_mask:0xf bank_mask:0x3
    v_add_f32_dpp v18, v18, v18 row_ror:8 row_mask:0xf bank_mask:0x3
    v_add_f32_dpp v17, v19, v19 row_ror:8 row_mask:0xf bank_mask:0xc
    v_add_f32_dpp v18, v20, v20 row_ror:8 row_mask:0xf bank_mask:0xc
    s_nop 1
    s_waitcnt vmcnt(7)
    buffer_load_dwordx4 v[112:115], v2, s[44:47], s64 offen offset:1024 nt
    v_add_f32_dpp v21, v17, v17 row_half_mirror row_mask:0xf bank_mask:0x5
    v_add_f32_dpp v21, v18, v18 row_half_mirror row_mask:0xf bank_mask:0xa
    s_nop 1
    v_add_f32_dpp v21, v21, v21 quad_perm:[1,0,3,2] row_mask:0xf bank_mask:0xf
    s_nop 1
    v_add_f32_dpp v21, v21, v21 quad_perm:[2,3,0,1] row_mask:0xf bank_mask:0xf
    v_cmp_gt_f32 vcc, v21, v11
    s_cbranch_vccnz SLOWA_9
BACKA_10:
    v_fma_f32 v25, v21, v5, -v12
    v_exp_f32 v25, v25
    s_waitcnt vmcnt(7)
    buffer_load_dwordx4 v[116:119], v2, s[44:47], s64 offen offset:2048 nt
    v_add_f32 v13, v13, v25
    v_cvt_pk_bf16_f32 v26, v25, v25
    s_waitcnt vmcnt(7)
    buffer_load_dwordx4 v[120:123], v2, s[44:47], s64 offen offset:3072 nt
    v_and_b32_dpp v30, v26, v3 row_newbcast:0 row_mask:0xf bank_mask:0xf
    v_and_b32_dpp v31, v26, v4 row_newbcast:0 row_mask:0xf bank_mask:0xf
    v_and_b32_dpp v32, v26, v3 row_newbcast:4 row_mask:0xf bank_mask:0xf
    v_and_b32_dpp v33, v26, v4 row_newbcast:4 row_mask:0xf bank_mask:0xf
    v_and_b32_dpp v34, v26, v3 row_newbcast:8 row_mask:0xf bank_mask:0xf
    v_and_b32_dpp v35, v26, v4 row_newbcast:8 row_mask:0xf bank_mask:0xf
    v_and_b32_dpp v36, v26, v3 row_newbcast:12 row_mask:0xf bank_mask:0xf
    v_and_b32_dpp v37, v26, v4 row_newbcast:12 row_mask:0xf bank_mask:0xf
    s_nop 0
    v_mfma_f32_16x16x16_bf16 v[60:63], v[30:31], v[124:125], v[60:63]
    v_mfma_f32_16x16x16_bf16 v[64:67], v[30:31], v[126:127], v[64:67]
    s_waitcnt vmcnt(7)
    buffer_load_dwordx4 v[124:127], v2, s[48:51], s64 offen nt
    v_mfma_f32_16x16x16_bf16 v[60:63], v[32:33], v[128:129], v[60:63]
    v_mfma_f32_16x16x16_bf16 v[64:67], v[32:33], v[130:131], v[64:67]
    s_waitcnt vmcnt(7)
    buffer_load_dwordx4 v[128:131], v2, s[48:51], s64 offen offset:1024 nt
    v_mfma_f32_16x16x16_bf16 v[60:63], v[34:35], v[132:133], v[60:63]
    v_mfma_f32_16x16x16_bf16 v[64:67], v[34:35], v[134:135], v[64:67]
    s_waitcnt vmcnt(7)
    buffer_load_dwordx4 v[132:135], v2, s[48:51], s64 offen offset:2048 nt
    v_mfma_f32_16x16x16_bf16 v[60:63], v[36:37], v[136:137], v[60:63]
    v_mfma_f32_16x16x16_bf16 v[64:67], v[36:37], v[138:139], v[64:67]
    s_waitcnt vmcnt(7)
    buffer_load_dwordx4 v[136:139], v2, s[48:51], s64 offen offset:3072 nt
    v_dot2_f32_bf16 v17, v140, v40, 0
    v_dot2_f32_bf16 v18, v144, v40, 0
    v_dot2_f32_bf16 v19, v148, v40, 0
    v_dot2_f32_bf16 v20, v152, v40, 0
    v_dot2_f32_bf16 v17, v141, v41, v17
    v_dot2_f32_bf16 v18, v145, v41, v18
    v_dot2_f32_bf16 v19, v149, v41, v19
    v_dot2_f32_bf16 v20, v153, v41, v20
    v_dot2_f32_bf16 v17, v142, v42, v17
    v_dot2_f32_bf16 v18, v146, v42, v18
    v_dot2_f32_bf16 v19, v150, v42, v19
    v_dot2_f32_bf16 v20, v154, v42, v20
    v_dot2_f32_bf16 v17, v143, v43, v17
    v_dot2_f32_bf16 v18, v147, v43, v18
    v_dot2_f32_bf16 v19, v151, v43, v19
    v_dot2_f32_bf16 v20, v155, v43, v20
    s_waitcnt vmcnt(7)
    buffer_load_dwordx4 v[140:143], v2, s[44:47], s65 offen nt
    s_nop 0
    v_add_f32_dpp v17, v17, v17 row_ror:8 row_mask:0xf bank_mask:0x3
    v_add_f32_dpp v18, v18, v18 row_ror:8 row_mask:0xf bank_mask:0x3
    v_add_f32_dpp v17, v19, v19 row_ror:8 row_mask:0xf bank_mask:0xc
    v_add_f32_dpp v18, v20, v20 row_ror:8 row_mask:0xf bank_mask:0xc
    s_nop 1
    s_waitcnt vmcnt(7)
    buffer_load_dwordx4 v[144:147], v2, s[44:47], s65 offen offset:1024 nt
    v_add_f32_dpp v21, v17, v17 row_half_mirror row_mask:0xf bank_mask:0x5
    v_add_f32_dpp v21, v18, v18 row_half_mirror row_mask:0xf bank_mask:0xa
    s_nop 1
    v_add_f32_dpp v21, v21, v21 quad_perm:[1,0,3,2] row_mask:0xf bank_mask:0xf
    s_nop 1
    v_add_f32_dpp v21, v21, v21 quad_perm:[2,3,0,1] row_mask:0xf bank_mask:0xf
    v_cmp_gt_f32 vcc, v21, v11
    s_cbranch_vccnz SLOWA_11
BACKA_12:
    v_fma_f32 v25, v21, v5, -v12
    v_exp_f32 v25, v25
    s_waitcnt vmcnt(7)
    buffer_load_dwordx4 v[148:151], v2, s[44:47], s65 offen offset:2048 nt
    v_add_f32 v13, v13, v25
    v_cvt_pk_bf16_f32 v26, v25, v25
    s_waitcnt vmcnt(7)
    buffer_load_dwordx4 v[152:155], v2, s[44:47], s65 offen offset:3072 nt
    v_and_b32_dpp v30, v26, v3 row_newbcast:0 row_mask:0xf bank_mask:0xf
    v_and_b32_dpp v31, v26, v4 row_newbcast:0 row_mask:0xf bank_mask:0xf
    v_and_b32_dpp v32, v26, v3 row_newbcast:4 row_mask:0xf bank_mask:0xf
    v_and_b32_dpp v33, v26, v4 row_newbcast:4 row_mask:0xf bank_mask:0xf
    v_and_b32_dpp v34, v26, v3 row_newbcast:8 row_mask:0xf bank_mask:0xf
    v_and_b32_dpp v35, v26, v4 row_newbcast:8 row_mask:0xf bank_mask:0xf
    v_and_b32_dpp v36, v26, v3 row_newbcast:12 row_mask:0xf bank_mask:0xf
    v_and_b32_dpp v37, v26, v4 row_newbcast:12 row_mask:0xf bank_mask:0xf
    s_nop 0
    v_mfma_f32_16x16x16_bf16 v[60:63], v[30:31], v[156:157], v[60:63]
    v_mfma_f32_16x16x16_bf16 v[64:67], v[30:31], v[158:159], v[64:67]
    s_waitcnt vmcnt(7)
    buffer_load_dwordx4 v[156:159], v2, s[48:51], s65 offen nt
    v_mfma_f32_16x16x16_bf16 v[60:63], v[32:33], v[160:161], v[60:63]
    v_mfma_f32_16x16x16_bf16 v[64:67], v[32:33], v[162:163], v[64:67]
    s_waitcnt vmcnt(7)
    buffer_load_dwordx4 v[160:163], v2, s[48:51], s65 offen offset:1024 nt
    v_mfma_f32_16x16x16_bf16 v[60:63], v[34:35], v[164:165], v[60:63]
    v_mfma_f32_16x16x16_bf16 v[64:67], v[34:35], v[166:167], v[64:67]
    s_waitcnt vmcnt(7)
    buffer_load_dwordx4 v[164:167], v2, s[48:51], s65 offen offset:2048 nt
    v_mfma_f32_16x16x16_bf16 v[60:63], v[36:37], v[168:169], v[60:63]
    v_mfma_f32_16x16x16_bf16 v[64:67], v[36:37], v[170:171], v[64:67]
    s_waitcnt vmcnt(7)
    buffer_load_dwordx4 v[168:171], v2, s[48:51], s65 offen offset:3072 nt
    v_dot2_f32_bf16 v17, v172, v40, 0
    v_dot2_f32_bf16 v18, v176, v40, 0
    v_dot2_f32_bf16 v19, v180, v40, 0
    v_dot2_f32_bf16 v20, v184, v40, 0
    v_dot2_f32_bf16 v17, v173, v41, v17
    v_dot2_f32_bf16 v18, v177, v41, v18
    v_dot2_f32_bf16 v19, v181, v41, v19
    v_dot2_f32_bf16 v20, v185, v41, v20
    v_dot2_f32_bf16 v17, v174, v42, v17
    v_dot2_f32_bf16 v18, v178, v42, v18
    v_dot2_f32_bf16 v19, v182, v42, v19
    v_dot2_f32_bf16 v20, v186, v42, v20
    v_dot2_f32_bf16 v17, v175, v43, v17
    v_dot2_f32_bf16 v18, v179, v43, v18
    v_dot2_f32_bf16 v19, v183, v43, v19
    v_dot2_f32_bf16 v20, v187, v43, v20
    s_waitcnt vmcnt(7)
    buffer_load_dwordx4 v[172:175], v2, s[44:47], s66 offen nt
    s_nop 0
    v_add_f32_dpp v17, v17, v17 row_ror:8 row_mask:0xf bank_mask:0x3
    v_add_f32_dpp v18, v18, v18 row_ror:8 row_mask:0xf bank_mask:0x3
    v_add_f32_dpp v17, v19, v19 row_ror:8 row_mask:0xf bank_mask:0xc
    v_add_f32_dpp v18, v20, v20 row_ror:8 row_mask:0xf bank_mask:0xc
    s_nop 1
    s_waitcnt vmcnt(7)
    buffer_load_dwordx4 v[176:179], v2, s[44:47], s66 offen offset:1024 nt
    v_add_f32_dpp v21, v17, v17 row_half_mirror row_mask:0xf bank_mask:0x5
    v_add_f32_dpp v21, v18, v18 row_half_mirror row_mask:0xf bank_mask:0xa
    s_nop 1
    v_add_f32_dpp v21, v21, v21 quad_perm:[1,0,3,2] row_mask:0xf bank_mask:0xf
    s_nop 1
    v_add_f32_dpp v21, v21, v21 quad_perm:[2,3,0,1] row_mask:0xf bank_mask:0xf
    v_cmp_gt_f32 vcc, v21, v11
    s_cbranch_vccnz SLOWA_13
BACKA_14:
    v_fma_f32 v25, v21, v5, -v12
    v_exp_f32 v25, v25
    s_waitcnt vmcnt(7)
    buffer_load_dwordx4 v[180:183], v2, s[44:47], s66 offen offset:2048 nt
    v_add_f32 v13, v13, v25
    v_cvt_pk_bf16_f32 v26, v25, v25
    s_waitcnt vmcnt(7)
    buffer_load_dwordx4 v[184:187], v2, s[44:47], s66 offen offset:3072 nt
    v_and_b32_dpp v30, v26, v3 row_newbcast:0 row_mask:0xf bank_mask:0xf
    v_and_b32_dpp v31, v26, v4 row_newbcast:0 row_mask:0xf bank_mask:0xf
    v_and_b32_dpp v32, v26, v3 row_newbcast:4 row_mask:0xf bank_mask:0xf
    v_and_b32_dpp v33, v26, v4 row_newbcast:4 row_mask:0xf bank_mask:0xf
    v_and_b32_dpp v34, v26, v3 row_newbcast:8 row_mask:0xf bank_mask:0xf
    v_and_b32_dpp v35, v26, v4 row_newbcast:8 row_mask:0xf bank_mask:0xf
    v_and_b32_dpp v36, v26, v3 row_newbcast:12 row_mask:0xf bank_mask:0xf
    v_and_b32_dpp v37, v26, v4 row_newbcast:12 row_mask:0xf bank_mask:0xf
    s_nop 0
    v_mfma_f32_16x16x16_bf16 v[60:63], v[30:31], v[188:189], v[60:63]
    v_mfma_f32_16x16x16_bf16 v[64:67], v[30:31], v[190:191], v[64:67]
    s_waitcnt vmcnt(7)
    buffer_load_dwordx4 v[188:191], v2, s[48:51], s66 offen nt
    v_mfma_f32_16x16x16_bf16 v[60:63], v[32:33], v[192:193], v[60:63]
    v_mfma_f32_16x16x16_bf16 v[64:67], v[32:33], v[194:195], v[64:67]
    s_waitcnt vmcnt(7)
    buffer_load_dwordx4 v[192:195], v2, s[48:51], s66 offen offset:1024 nt
    v_mfma_f32_16x16x16_bf16 v[60:63], v[34:35], v[196:197], v[60:63]
    v_mfma_f32_16x16x16_bf16 v[64:67], v[34:35], v[198:199], v[64:67]
    s_waitcnt vmcnt(7)
    buffer_load_dwordx4 v[196:199], v2, s[48:51], s66 offen offset:2048 nt
    v_mfma_f32_16x16x16_bf16 v[60:63], v[36:37], v[200:201], v[60:63]
    v_mfma_f32_16x16x16_bf16 v[64:67], v[36:37], v[202:203], v[64:67]
    s_waitcnt vmcnt(7)
    buffer_load_dwordx4 v[200:203], v2, s[48:51], s66 offen offset:3072 nt
    v_dot2_f32_bf16 v17, v204, v40, 0
    v_dot2_f32_bf16 v18, v208, v40, 0
    v_dot2_f32_bf16 v19, v212, v40, 0
    v_dot2_f32_bf16 v20, v216, v40, 0
    v_dot2_f32_bf16 v17, v205, v41, v17
    v_dot2_f32_bf16 v18, v209, v41, v18
    v_dot2_f32_bf16 v19, v213, v41, v19
    v_dot2_f32_bf16 v20, v217, v41, v20
    v_dot2_f32_bf16 v17, v206, v42, v17
    v_dot2_f32_bf16 v18, v210, v42, v18
    v_dot2_f32_bf16 v19, v214, v42, v19
    v_dot2_f32_bf16 v20, v218, v42, v20
    v_dot2_f32_bf16 v17, v207, v43, v17
    v_dot2_f32_bf16 v18, v211, v43, v18
    v_dot2_f32_bf16 v19, v215, v43, v19
    v_dot2_f32_bf16 v20, v219, v43, v20
    s_waitcnt vmcnt(7)
    buffer_load_dwordx4 v[204:207], v2, s[44:47], s67 offen nt
    s_nop 0
    v_add_f32_dpp v17, v17, v17 row_ror:8 row_mask:0xf bank_mask:0x3
    v_add_f32_dpp v18, v18, v18 row_ror:8 row_mask:0xf bank_mask:0x3
    v_add_f32_dpp v17, v19, v19 row_ror:8 row_mask:0xf bank_mask:0xc
    v_add_f32_dpp v18, v20, v20 row_ror:8 row_mask:0xf bank_mask:0xc
    s_nop 1
    s_waitcnt vmcnt(7)
    buffer_load_dwordx4 v[208:211], v2, s[44:47], s67 offen offset:1024 nt
    v_add_f32_dpp v21, v17, v17 row_half_mirror row_mask:0xf bank_mask:0x5
    v_add_f32_dpp v21, v18, v18 row_half_mirror row_mask:0xf bank_mask:0xa
    s_nop 1
    v_add_f32_dpp v21, v21, v21 quad_perm:[1,0,3,2] row_mask:0xf bank_mask:0xf
    s_nop 1
    v_add_f32_dpp v21, v21, v21 quad_perm:[2,3,0,1] row_mask:0xf bank_mask:0xf
    v_cmp_gt_f32 vcc, v21, v11
    s_cbranch_vccnz SLOWA_15
BACKA_16:
    v_fma_f32 v25, v21, v5, -v12
    v_exp_f32 v25, v25
    s_waitcnt vmcnt(7)
    buffer_load_dwordx4 v[212:215], v2, s[44:47], s67 offen offset:2048 nt
    v_add_f32 v13, v13, v25
    v_cvt_pk_bf16_f32 v26, v25, v25
    s_waitcnt vmcnt(7)
    buffer_load_dwordx4 v[216:219], v2, s[44:47], s67 offen offset:3072 nt
    v_and_b32_dpp v30, v26, v3 row_newbcast:0 row_mask:0xf bank_mask:0xf
    v_and_b32_dpp v31, v26, v4 row_newbcast:0 row_mask:0xf bank_mask:0xf
    v_and_b32_dpp v32, v26, v3 row_newbcast:4 row_mask:0xf bank_mask:0xf
    v_and_b32_dpp v33, v26, v4 row_newbcast:4 row_mask:0xf bank_mask:0xf
    v_and_b32_dpp v34, v26, v3 row_newbcast:8 row_mask:0xf bank_mask:0xf
    v_and_b32_dpp v35, v26, v4 row_newbcast:8 row_mask:0xf bank_mask:0xf
    v_and_b32_dpp v36, v26, v3 row_newbcast:12 row_mask:0xf bank_mask:0xf
    v_and_b32_dpp v37, v26, v4 row_newbcast:12 row_mask:0xf bank_mask:0xf
    s_nop 0
    v_mfma_f32_16x16x16_bf16 v[60:63], v[30:31], v[220:221], v[60:63]
    v_mfma_f32_16x16x16_bf16 v[64:67], v[30:31], v[222:223], v[64:67]
    s_waitcnt vmcnt(7)
    buffer_load_dwordx4 v[220:223], v2, s[48:51], s67 offen nt
    v_mfma_f32_16x16x16_bf16 v[60:63], v[32:33], v[224:225], v[60:63]
    v_mfma_f32_16x16x16_bf16 v[64:67], v[32:33], v[226:227], v[64:67]
    s_waitcnt vmcnt(7)
    buffer_load_dwordx4 v[224:227], v2, s[48:51], s67 offen offset:1024 nt
    v_mfma_f32_16x16x16_bf16 v[60:63], v[34:35], v[228:229], v[60:63]
    v_mfma_f32_16x16x16_bf16 v[64:67], v[34:35], v[230:231], v[64:67]
    s_waitcnt vmcnt(7)
    buffer_load_dwordx4 v[228:231], v2, s[48:51], s67 offen offset:2048 nt
    v_mfma_f32_16x16x16_bf16 v[60:63], v[36:37], v[232:233], v[60:63]
    v_mfma_f32_16x16x16_bf16 v[64:67], v[36:37], v[234:235], v[64:67]
    s_waitcnt vmcnt(7)
    buffer_load_dwordx4 v[232:235], v2, s[48:51], s67 offen offset:3072 nt
    s_cmp_lg_u32 s9, 19
    s_cbranch_scc1 LOOP_HI
    s_branch LOOP_A2
LOOP_LO:
    v_mov_b32 v9, 0
    v_mov_b32 v8, s9
    s_mov_b64 exec, 1
    ds_max_u32 v9, v8 offset:4172
    s_mov_b64 exec, -1
    s_sub_u32 s10, s9, 7
    s_cmp_lt_u32 s10, 4
    s_cselect_b64 s[44:45], s[60:61], s[56:57]
    s_cselect_b64 s[48:49], s[62:63], s[58:59]
    s_mov_b32 s11, 0x100000
    s_cselect_b32 s46, 0x40000, s11
    s_mov_b32 s50, s46
    s_cselect_b32 s10, s10, s9
    s_sub_u32 s11, s9, 4
    s_cmp_ge_u32 s9, 11
    s_cselect_b32 s10, s11, s10
    s_lshl_b32 s64, s10, 16
    s_add_u32 s65, s64, 16384
    s_add_u32 s66, s64, 32768
    s_add_u32 s67, s64, 49152
    s_add_u32 s9, s9, 1
    v_dot2_f32_bf16 v17, v108, v40, 0
    v_dot2_f32_bf16 v18, v112, v40, 0
    v_dot2_f32_bf16 v19, v116, v40, 0
    v_dot2_f32_bf16 v20, v120, v40, 0
    v_dot2_f32_bf16 v17, v109, v41, v17
    v_dot2_f32_bf16 v18, v113, v41, v18
    v_dot2_f32_bf16 v19, v117, v41, v19
    v_dot2_f32_bf16 v20, v121, v41, v20
    v_dot2_f32_bf16 v17, v110, v42, v17
    v_dot2_f32_bf16 v18, v114, v42, v18
    v_dot2_f32_bf16 v19, v118, v42, v19
    v_dot2_f32_bf16 v20, v122, v42, v20
    v_dot2_f32_bf16 v17, v111, v43, v17
    v_dot2_f32_bf16 v18, v115, v43, v18
    v_dot2_f32_bf16 v19, v119, v43, v19
    v_dot2_f32_bf16 v20, v123, v43, v20
    s_waitcnt vmcnt(4)
    buffer_load_dwordx4 v[108:111], v2, s[44:47], s64 offen nt
    s_nop 0
    v_add_f32_dpp v17, v17, v17 row_ror:8 row_mask:0xf bank_mask:0x3
    v_add_f32_dpp v18, v18, v18 row_ror:8 row_mask:0xf bank_mask:0x3
    v_add_f32_dpp v17, v19, v19 row_ror:8 row_mask:0xf bank_mask:0xc
    v_add_f32_dpp v18, v20, v20 row_ror:8 row_mask:0xf bank_mask:0xc
    s_nop 1
    s_waitcnt vmcnt(4)
    buffer_load_dwordx4 v[112:115], v2, s[44:47], s64 offen offset:1024 nt
    v_add_f32_dpp v21, v17, v17 row_half_mirror row_mask:0xf bank_mask:0x5
    v_add_f32_dpp v21, v18, v18 row_half_mirror row_mask:0xf bank_mask:0xa
    s_nop 1
    v_add_f32_dpp v21, v21, v21 quad_perm:[1,0,3,2] row_mask:0xf bank_mask:0xf
    s_nop 1
    v_add_f32_dpp v21, v21, v21 quad_perm:[2,3,0,1] row_mask:0xf bank_mask:0xf
    v_cmp_gt_f32 vcc, v21, v11
    s_cbranch_vccnz SLOWA_17
BACKA_18:
    v_fma_f32 v25, v21, v5, -v12
    v_exp_f32 v25, v25
    s_waitcnt vmcnt(4)
    buffer_load_dwordx4 v[116:119], v2, s[44:47], s64 offen offset:2048 nt
    v_add_f32 v13, v13, v25
    v_cvt_pk_bf16_f32 v26, v25, v25
    s_waitcnt vmcnt(4)
    buffer_load_dwordx4 v[120:123], v2, s[44:47], s64 offen offset:3072 nt
    v_and_b32_dpp v30, v26, v3 row_newbcast:0 row_mask:0xf bank_mask:0xf
    v_and_b32_dpp v31, v26, v4 row_newbcast:0 row_mask:0xf bank_mask:0xf
    v_and_b32_dpp v32, v26, v3 row_newbcast:4 row_mask:0xf bank_mask:0xf
    v_and_b32_dpp v33, v26, v4 row_newbcast:4 row_mask:0xf bank_mask:0xf
    v_and_b32_dpp v34, v26, v3 row_newbcast:8 row_mask:0xf bank_mask:0xf
    v_and_b32_dpp v35, v26, v4 row_newbcast:8 row_mask:0xf bank_mask:0xf
    v_and_b32_dpp v36, v26, v3 row_newbcast:12 row_mask:0xf bank_mask:0xf
    v_and_b32_dpp v37, v26, v4 row_newbcast:12 row_mask:0xf bank_mask:0xf
    s_nop 0
    v_mfma_f32_16x16x16_bf16 v[60:63], v[30:31], v[124:125], v[60:63]
    v_mfma_f32_16x16x16_bf16 v[64:67], v[30:31], v[126:127], v[64:67]
    s_waitcnt vmcnt(4)
    buffer_load_dwordx4 v[124:127], v2, s[48:51], s64 offen nt
    v_mfma_f32_16x16x16_bf16 v[60:63], v[32:33], v[128:129], v[60:63]
    v_mfma_f32_16x16x16_bf16 v[64:67], v[32:33], v[130:131], v[64:67]
    s_waitcnt vmcnt(4)
    buffer_load_dwordx4 v[128:131], v2, s[48:51], s64 offen offset:1024 nt
    v_mfma_f32_16x16x16_bf16 v[60:63], v[34:35], v[132:133], v[60:63]
    v_mfma_f32_16x16x16_bf16 v[64:67], v[34:35], v[134:135], v[64:67]
    s_waitcnt vmcnt(4)
    buffer_load_dwordx4 v[132:135], v2, s[48:51], s64 offen offset:2048 nt
    v_mfma_f32_16x16x16_bf16 v[60:63], v[36:37], v[136:137], v[60:63]
    v_mfma_f32_16x16x16_bf16 v[64:67], v[36:37], v[138:139], v[64:67]
    s_waitcnt vmcnt(4)
    buffer_load_dwordx4 v[136:139], v2, s[48:51], s64 offen offset:3072 nt
    v_dot2_f32_bf16 v17, v140, v40, 0
    v_dot2_f32_bf16 v18, v144, v40, 0
    v_dot2_f32_bf16 v19, v148, v40, 0
    v_dot2_f32_bf16 v20, v152, v40, 0
    v_dot2_f32_bf16 v17, v141, v41, v17
    v_dot2_f32_bf16 v18, v145, v41, v18
    v_dot2_f32_bf16 v19, v149, v41, v19
    v_dot2_f32_bf16 v20, v153, v41, v20
    v_dot2_f32_bf16 v17, v142, v42, v17
    v_dot2_f32_bf16 v18, v146, v42, v18
    v_dot2_f32_bf16 v19, v150, v42, v19
    v_dot2_f32_bf16 v20, v154, v42, v20
    v_dot2_f32_bf16 v17, v143, v43, v17
    v_dot2_f32_bf16 v18, v147, v43, v18
    v_dot2_f32_bf16 v19, v151, v43, v19
    v_dot2_f32_bf16 v20, v155, v43, v20
    s_waitcnt vmcnt(4)
    buffer_load_dwordx4 v[140:143], v2, s[44:47], s65 offen nt
    s_nop 0
    v_add_f32_dpp v17, v17, v17 row_ror:8 row_mask:0xf bank_mask:0x3
    v_add_f32_dpp v18, v18, v18 row_ror:8 row_mask:0xf bank_mask:0x3
    v_add_f32_dpp v17, v19, v19 row_ror:8 row_mask:0xf bank_mask:0xc
    v_add_f32_dpp v18, v20, v20 row_ror:8 row_mask:0xf bank_mask:0xc
    s_nop 1
    s_waitcnt vmcnt(4)
    buffer_load_dwordx4 v[144:147], v2, s[44:47], s65 offen offset:1024 nt
    v_add_f32_dpp v21, v17, v17 row_half_mirror row_mask:0xf bank_mask:0x5
    v_add_f32_dpp v21, v18, v18 row_half_mirror row_mask:0xf bank_mask:0xa
    s_nop 1
    v_add_f32_dpp v21, v21, v21 quad_perm:[1,0,3,2] row_mask:0xf bank_mask:0xf
    s_nop 1
    v_add_f32_dpp v21, v21, v21 quad_perm:[2,3,0,1] row_mask:0xf bank_mask:0xf
    v_cmp_gt_f32 vcc, v21, v11
    s_cbranch_vccnz SLOWA_19
BACKA_20:
    v_fma_f32 v25, v21, v5, -v12
    v_exp_f32 v25, v25
    s_waitcnt vmcnt(4)
    buffer_load_dwordx4 v[148:151], v2, s[44:47], s65 offen offset:2048 nt
    v_add_f32 v13, v13, v25
    v_cvt_pk_bf16_f32 v26, v25, v25
    s_waitcnt vmcnt(4)
    buffer_load_dwordx4 v[152:155], v2, s[44:47], s65 offen offset:3072 nt
    v_and_b32_dpp v30, v26, v3 row_newbcast:0 row_mask:0xf bank_mask:0xf
    v_and_b32_dpp v31, v26, v4 row_newbcast:0 row_mask:0xf bank_mask:0xf
    v_and_b32_dpp v32, v26, v3 row_newbcast:4 row_mask:0xf bank_mask:0xf
    v_and_b32_dpp v33, v26, v4 row_newbcast:4 row_mask:0xf bank_mask:0xf
    v_and_b32_dpp v34, v26, v3 row_newbcast:8 row_mask:0xf bank_mask:0xf
    v_and_b32_dpp v35, v26, v4 row_newbcast:8 row_mask:0xf bank_mask:0xf
    v_and_b32_dpp v36, v26, v3 row_newbcast:12 row_mask:0xf bank_mask:0xf
    v_and_b32_dpp v37, v26, v4 row_newbcast:12 row_mask:0xf bank_mask:0xf
    s_nop 0
    v_mfma_f32_16x16x16_bf16 v[60:63], v[30:31], v[156:157], v[60:63]
    v_mfma_f32_16x16x16_bf16 v[64:67], v[30:31], v[158:159], v[64:67]
    s_waitcnt vmcnt(4)
    buffer_load_dwordx4 v[156:159], v2, s[48:51], s65 offen nt
    v_mfma_f32_16x16x16_bf16 v[60:63], v[32:33], v[160:161], v[60:63]
    v_mfma_f32_16x16x16_bf16 v[64:67], v[32:33], v[162:163], v[64:67]
    s_waitcnt vmcnt(4)
    buffer_load_dwordx4 v[160:163], v2, s[48:51], s65 offen offset:1024 nt
    v_mfma_f32_16x16x16_bf16 v[60:63], v[34:35], v[164:165], v[60:63]
    v_mfma_f32_16x16x16_bf16 v[64:67], v[34:35], v[166:167], v[64:67]
    s_waitcnt vmcnt(4)
    buffer_load_dwordx4 v[164:167], v2, s[48:51], s65 offen offset:2048 nt
    v_mfma_f32_16x16x16_bf16 v[60:63], v[36:37], v[168:169], v[60:63]
    v_mfma_f32_16x16x16_bf16 v[64:67], v[36:37], v[170:171], v[64:67]
    s_waitcnt vmcnt(4)
    buffer_load_dwordx4 v[168:171], v2, s[48:51], s65 offen offset:3072 nt
    v_dot2_f32_bf16 v17, v172, v40, 0
    v_dot2_f32_bf16 v18, v176, v40, 0
    v_dot2_f32_bf16 v19, v180, v40, 0
    v_dot2_f32_bf16 v20, v184, v40, 0
    v_dot2_f32_bf16 v17, v173, v41, v17
    v_dot2_f32_bf16 v18, v177, v41, v18
    v_dot2_f32_bf16 v19, v181, v41, v19
    v_dot2_f32_bf16 v20, v185, v41, v20
    v_dot2_f32_bf16 v17, v174, v42, v17
    v_dot2_f32_bf16 v18, v178, v42, v18
    v_dot2_f32_bf16 v19, v182, v42, v19
    v_dot2_f32_bf16 v20, v186, v42, v20
    v_dot2_f32_bf16 v17, v175, v43, v17
    v_dot2_f32_bf16 v18, v179, v43, v18
    v_dot2_f32_bf16 v19, v183, v43, v19
    v_dot2_f32_bf16 v20, v187, v43, v20
    s_waitcnt vmcnt(4)
    buffer_load_dwordx4 v[172:175], v2, s[44:47], s66 offen nt
    s_nop 0
    v_add_f32_dpp v17, v17, v17 row_ror:8 row_mask:0xf bank_mask:0x3
    v_add_f32_dpp v18, v18, v18 row_ror:8 row_mask:0xf bank_mask:0x3
    v_add_f32_dpp v17, v19, v19 row_ror:8 row_mask:0xf bank_mask:0xc
    v_add_f32_dpp v18, v20, v20 row_ror:8 row_mask:0xf bank_mask:0xc
    s_nop 1
    s_waitcnt vmcnt(4)
    buffer_load_dwordx4 v[176:179], v2, s[44:47], s66 offen offset:1024 nt
    v_add_f32_dpp v21, v17, v17 row_half_mirror row_mask:0xf bank_mask:0x5
    v_add_f32_dpp v21, v18, v18 row_half_mirror row_mask:0xf bank_mask:0xa
    s_nop 1
    v_add_f32_dpp v21, v21, v21 quad_perm:[1,0,3,2] row_mask:0xf bank_mask:0xf
    s_nop 1
    v_add_f32_dpp v21, v21, v21 quad_perm:[2,3,0,1] row_mask:0xf bank_mask:0xf
    v_cmp_gt_f32 vcc, v21, v11
    s_cbranch_vccnz SLOWA_21
BACKA_22:
    v_fma_f32 v25, v21, v5, -v12
    v_exp_f32 v25, v25
    s_waitcnt vmcnt(4)
    buffer_load_dwordx4 v[180:183], v2, s[44:47], s66 offen offset:2048 nt
    v_add_f32 v13, v13, v25
    v_cvt_pk_bf16_f32 v26, v25, v25
    s_waitcnt vmcnt(4)
    buffer_load_dwordx4 v[184:187], v2, s[44:47], s66 offen offset:3072 nt
    v_and_b32_dpp v30, v26, v3 row_newbcast:0 row_mask:0xf bank_mask:0xf
    v_and_b32_dpp v31, v26, v4 row_newbcast:0 row_mask:0xf bank_mask:0xf
    v_and_b32_dpp v32, v26, v3 row_newbcast:4 row_mask:0xf bank_mask:0xf
    v_and_b32_dpp v33, v26, v4 row_newbcast:4 row_mask:0xf bank_mask:0xf
    v_and_b32_dpp v34, v26, v3 row_newbcast:8 row_mask:0xf bank_mask:0xf
    v_and_b32_dpp v35, v26, v4 row_newbcast:8 row_mask:0xf bank_mask:0xf
    v_and_b32_dpp v36, v26, v3 row_newbcast:12 row_mask:0xf bank_mask:0xf
    v_and_b32_dpp v37, v26, v4 row_newbcast:12 row_mask:0xf bank_mask:0xf
    s_nop 0
    v_mfma_f32_16x16x16_bf16 v[60:63], v[30:31], v[188:189], v[60:63]
    v_mfma_f32_16x16x16_bf16 v[64:67], v[30:31], v[190:191], v[64:67]
    s_waitcnt vmcnt(4)
    buffer_load_dwordx4 v[188:191], v2, s[48:51], s66 offen nt
    v_mfma_f32_16x16x16_bf16 v[60:63], v[32:33], v[192:193], v[60:63]
    v_mfma_f32_16x16x16_bf16 v[64:67], v[32:33], v[194:195], v[64:67]
    s_waitcnt vmcnt(4)
    buffer_load_dwordx4 v[192:195], v2, s[48:51], s66 offen offset:1024 nt
    v_mfma_f32_16x16x16_bf16 v[60:63], v[34:35], v[196:197], v[60:63]
    v_mfma_f32_16x16x16_bf16 v[64:67], v[34:35], v[198:199], v[64:67]
    s_waitcnt vmcnt(4)
    buffer_load_dwordx4 v[196:199], v2, s[48:51], s66 offen offset:2048 nt
    v_mfma_f32_16x16x16_bf16 v[60:63], v[36:37], v[200:201], v[60:63]
    v_mfma_f32_16x16x16_bf16 v[64:67], v[36:37], v[202:203], v[64:67]
    s_waitcnt vmcnt(4)
    buffer_load_dwordx4 v[200:203], v2, s[48:51], s66 offen offset:3072 nt
    v_dot2_f32_bf16 v17, v204, v40, 0
    v_dot2_f32_bf16 v18, v208, v40, 0
    v_dot2_f32_bf16 v19, v212, v40, 0
    v_dot2_f32_bf16 v20, v216, v40, 0
    v_dot2_f32_bf16 v17, v205, v41, v17
    v_dot2_f32_bf16 v18, v209, v41, v18
    v_dot2_f32_bf16 v19, v213, v41, v19
    v_dot2_f32_bf16 v20, v217, v41, v20
    v_dot2_f32_bf16 v17, v206, v42, v17
    v_dot2_f32_bf16 v18, v210, v42, v18
    v_dot2_f32_bf16 v19, v214, v42, v19
    v_dot2_f32_bf16 v20, v218, v42, v20
    v_dot2_f32_bf16 v17, v207, v43, v17
    v_dot2_f32_bf16 v18, v211, v43, v18
    v_dot2_f32_bf16 v19, v215, v43, v19
    v_dot2_f32_bf16 v20, v219, v43, v20
    s_waitcnt vmcnt(4)
    buffer_load_dwordx4 v[204:207], v2, s[44:47], s67 offen nt
    s_nop 0
    v_add_f32_dpp v17, v17, v17 row_ror:8 row_mask:0xf bank_mask:0x3
    v_add_f32_dpp v18, v18, v18 row_ror:8 row_mask:0xf bank_mask:0x3
    v_add_f32_dpp v17, v19, v19 row_ror:8 row_mask:0xf bank_mask:0xc
    v_add_f32_dpp v18, v20, v20 row_ror:8 row_mask:0xf bank_mask:0xc
    s_nop 1
    s_waitcnt vmcnt(4)
    buffer_load_dwordx4 v[208:211], v2, s[44:47], s67 offen offset:1024 nt
    v_add_f32_dpp v21, v17, v17 row_half_mirror row_mask:0xf bank_mask:0x5
    v_add_f32_dpp v21, v18, v18 row_half_mirror row_mask:0xf bank_mask:0xa
    s_nop 1
    v_add_f32_dpp v21, v21, v21 quad_perm:[1,0,3,2] row_mask:0xf bank_mask:0xf
    s_nop 1
    v_add_f32_dpp v21, v21, v21 quad_perm:[2,3,0,1] row_mask:0xf bank_mask:0xf
    v_cmp_gt_f32 vcc, v21, v11
    s_cbranch_vccnz SLOWA_23
BACKA_24:
    v_fma_f32 v25, v21, v5, -v12
    v_exp_f32 v25, v25
    s_waitcnt vmcnt(4)
    buffer_load_dwordx4 v[212:215], v2, s[44:47], s67 offen offset:2048 nt
    v_add_f32 v13, v13, v25
    v_cvt_pk_bf16_f32 v26, v25, v25
    s_waitcnt vmcnt(4)
    buffer_load_dwordx4 v[216:219], v2, s[44:47], s67 offen offset:3072 nt
    v_and_b32_dpp v30, v26, v3 row_newbcast:0 row_mask:0xf bank_mask:0xf
    v_and_b32_dpp v31, v26, v4 row_newbcast:0 row_mask:0xf bank_mask:0xf
    v_and_b32_dpp v32, v26, v3 row_newbcast:4 row_mask:0xf bank_mask:0xf
    v_and_b32_dpp v33, v26, v4 row_newbcast:4 row_mask:0xf bank_mask:0xf
    v_and_b32_dpp v34, v26, v3 row_newbcast:8 row_mask:0xf bank_mask:0xf
    v_and_b32_dpp v35, v26, v4 row_newbcast:8 row_mask:0xf bank_mask:0xf
    v_and_b32_dpp v36, v26, v3 row_newbcast:12 row_mask:0xf bank_mask:0xf
    v_and_b32_dpp v37, v26, v4 row_newbcast:12 row_mask:0xf bank_mask:0xf
    s_nop 0
    v_mfma_f32_16x16x16_bf16 v[60:63], v[30:31], v[220:221], v[60:63]
    v_mfma_f32_16x16x16_bf16 v[64:67], v[30:31], v[222:223], v[64:67]
    s_waitcnt vmcnt(4)
    buffer_load_dwordx4 v[220:223], v2, s[48:51], s67 offen nt
    v_mfma_f32_16x16x16_bf16 v[60:63], v[32:33], v[224:225], v[60:63]
    v_mfma_f32_16x16x16_bf16 v[64:67], v[32:33], v[226:227], v[64:67]
    s_waitcnt vmcnt(4)
    buffer_load_dwordx4 v[224:227], v2, s[48:51], s67 offen offset:1024 nt
    v_mfma_f32_16x16x16_bf16 v[60:63], v[34:35], v[228:229], v[60:63]
    v_mfma_f32_16x16x16_bf16 v[64:67], v[34:35], v[230:231], v[64:67]
    s_waitcnt vmcnt(4)
    buffer_load_dwordx4 v[228:231], v2, s[48:51], s67 offen offset:2048 nt
    v_mfma_f32_16x16x16_bf16 v[60:63], v[36:37], v[232:233], v[60:63]
    v_mfma_f32_16x16x16_bf16 v[64:67], v[36:37], v[234:235], v[64:67]
    s_waitcnt vmcnt(4)
    buffer_load_dwordx4 v[232:235], v2, s[48:51], s67 offen offset:3072 nt
    s_cmp_lg_u32 s9, 19
    s_cbranch_scc1 LOOP_LO
LOOP_A2:
    s_sub_u32 s10, s9, 7
    s_cmp_lt_u32 s10, 4
    s_cselect_b64 s[44:45], s[60:61], s[56:57]
    s_cselect_b64 s[48:49], s[62:63], s[58:59]
    s_mov_b32 s11, 0x100000
    s_cselect_b32 s46, 0x40000, s11
    s_mov_b32 s50, s46
    s_cselect_b32 s10, s10, s9
    s_sub_u32 s11, s9, 4
    s_cmp_ge_u32 s9, 11
    s_cselect_b32 s10, s11, s10
    s_lshl_b32 s64, s10, 16
    s_add_u32 s65, s64, 16384
    s_add_u32 s66, s64, 32768
    s_add_u32 s67, s64, 49152
    s_add_u32 s9, s9, 1
    v_dot2_f32_bf16 v17, v108, v40, 0
    v_dot2_f32_bf16 v18, v112, v40, 0
    v_dot2_f32_bf16 v19, v116, v40, 0
    v_dot2_f32_bf16 v20, v120, v40, 0
    v_dot2_f32_bf16 v17, v109, v41, v17
    v_dot2_f32_bf16 v18, v113, v41, v18
    v_dot2_f32_bf16 v19, v117, v41, v19
    v_dot2_f32_bf16 v20, v121, v41, v20
    v_dot2_f32_bf16 v17, v110, v42, v17
    v_dot2_f32_bf16 v18, v114, v42, v18
    v_dot2_f32_bf16 v19, v118, v42, v19
    v_dot2_f32_bf16 v20, v122, v42, v20
    v_dot2_f32_bf16 v17, v111, v43, v17
    v_dot2_f32_bf16 v18, v115, v43, v18
    v_dot2_f32_bf16 v19, v119, v43, v19
    v_dot2_f32_bf16 v20, v123, v43, v20
    s_waitcnt vmcnt(19)
    buffer_load_dwordx4 v[108:111], v2, s[44:47], s64 offen nt
    s_nop 0
    v_add_f32_dpp v17, v17, v17 row_ror:8 row_mask:0xf bank_mask:0x3
    v_add_f32_dpp v18, v18, v18 row_ror:8 row_mask:0xf bank_mask:0x3
    v_add_f32_dpp v17, v19, v19 row_ror:8 row_mask:0xf bank_mask:0xc
    v_add_f32_dpp v18, v20, v20 row_ror:8 row_mask:0xf bank_mask:0xc
    s_nop 1
    s_waitcnt vmcnt(19)
    buffer_load_dwordx4 v[112:115], v2, s[44:47], s64 offen offset:1024 nt
    v_add_f32_dpp v21, v17, v17 row_half_mirror row_mask:0xf bank_mask:0x5
    v_add_f32_dpp v21, v18, v18 row_half_mirror row_mask:0xf bank_mask:0xa
    s_nop 1
    v_add_f32_dpp v21, v21, v21 quad_perm:[1,0,3,2] row_mask:0xf bank_mask:0xf
    s_nop 1
    v_add_f32_dpp v21, v21, v21 quad_perm:[2,3,0,1] row_mask:0xf bank_mask:0xf
    v_cmp_gt_f32 vcc, v21, v11
    s_cbranch_vccnz SLOWA_25
BACKA_26:
    v_fma_f32 v25, v21, v5, -v12
    v_exp_f32 v25, v25
    s_waitcnt vmcnt(19)
    buffer_load_dwordx4 v[116:119], v2, s[44:47], s64 offen offset:2048 nt
    v_add_f32 v13, v13, v25
    v_cvt_pk_bf16_f32 v26, v25, v25
    s_waitcnt vmcnt(19)
    buffer_load_dwordx4 v[120:123], v2, s[44:47], s64 offen offset:3072 nt
    v_and_b32_dpp v30, v26, v3 row_newbcast:0 row_mask:0xf bank_mask:0xf
    v_and_b32_dpp v31, v26, v4 row_newbcast:0 row_mask:0xf bank_mask:0xf
    v_and_b32_dpp v32, v26, v3 row_newbcast:4 row_mask:0xf bank_mask:0xf
    v_and_b32_dpp v33, v26, v4 row_newbcast:4 row_mask:0xf bank_mask:0xf
    v_and_b32_dpp v34, v26, v3 row_newbcast:8 row_mask:0xf bank_mask:0xf
    v_and_b32_dpp v35, v26, v4 row_newbcast:8 row_mask:0xf bank_mask:0xf
    v_and_b32_dpp v36, v26, v3 row_newbcast:12 row_mask:0xf bank_mask:0xf
    v_and_b32_dpp v37, v26, v4 row_newbcast:12 row_mask:0xf bank_mask:0xf
    s_nop 0
    v_mfma_f32_16x16x16_bf16 v[60:63], v[30:31], v[124:125], v[60:63]
    v_mfma_f32_16x16x16_bf16 v[64:67], v[30:31], v[126:127], v[64:67]
    s_waitcnt vmcnt(19)
    buffer_load_dwordx4 v[124:127], v2, s[48:51], s64 offen nt
    v_mfma_f32_16x16x16_bf16 v[60:63], v[32:33], v[128:129], v[60:63]
    v_mfma_f32_16x16x16_bf16 v[64:67], v[32:33], v[130:131], v[64:67]
    s_waitcnt vmcnt(19)
    buffer_load_dwordx4 v[128:131], v2, s[48:51], s64 offen offset:1024 nt
    v_mfma_f32_16x16x16_bf16 v[60:63], v[34:35], v[132:133], v[60:63]
    v_mfma_f32_16x16x16_bf16 v[64:67], v[34:35], v[134:135], v[64:67]
    s_waitcnt vmcnt(19)
    buffer_load_dwordx4 v[132:135], v2, s[48:51], s64 offen offset:2048 nt
    v_mfma_f32_16x16x16_bf16 v[60:63], v[36:37], v[136:137], v[60:63]
    v_mfma_f32_16x16x16_bf16 v[64:67], v[36:37], v[138:139], v[64:67]
    s_waitcnt vmcnt(19)
    buffer_load_dwordx4 v[136:139], v2, s[48:51], s64 offen offset:3072 nt
    v_dot2_f32_bf16 v17, v140, v40, 0
    v_dot2_f32_bf16 v18, v144, v40, 0
    v_dot2_f32_bf16 v19, v148, v40, 0
    v_dot2_f32_bf16 v20, v152, v40, 0
    v_dot2_f32_bf16 v17, v141, v41, v17
    v_dot2_f32_bf16 v18, v145, v41, v18
    v_dot2_f32_bf16 v19, v149, v41, v19
    v_dot2_f32_bf16 v20, v153, v41, v20
    v_dot2_f32_bf16 v17, v142, v42, v17
    v_dot2_f32_bf16 v18, v146, v42, v18
    v_dot2_f32_bf16 v19, v150, v42, v19
    v_dot2_f32_bf16 v20, v154, v42, v20
    v_dot2_f32_bf16 v17, v143, v43, v17
    v_dot2_f32_bf16 v18, v147, v43, v18
    v_dot2_f32_bf16 v19, v151, v43, v19
    v_dot2_f32_bf16 v20, v155, v43, v20
    s_waitcnt vmcnt(19)
    buffer_load_dwordx4 v[140:143], v2, s[44:47], s65 offen nt
    s_nop 0
    v_add_f32_dpp v17, v17, v17 row_ror:8 row_mask:0xf bank_mask:0x3
    v_add_f32_dpp v18, v18, v18 row_ror:8 row_mask:0xf bank_mask:0x3
    v_add_f32_dpp v17, v19, v19 row_ror:8 row_mask:0xf bank_mask:0xc
    v_add_f32_dpp v18, v20, v20 row_ror:8 row_mask:0xf bank_mask:0xc
    s_nop 1
    s_waitcnt vmcnt(19)
    buffer_load_dwordx4 v[144:147], v2, s[44:47], s65 offen offset:1024 nt
    v_add_f32_dpp v21, v17, v17 row_half_mirror row_mask:0xf bank_mask:0x5
    v_add_f32_dpp v21, v18, v18 row_half_mirror row_mask:0xf bank_mask:0xa
    s_nop 1
    v_add_f32_dpp v21, v21, v21 quad_perm:[1,0,3,2] row_mask:0xf bank_mask:0xf
    s_nop 1
    v_add_f32_dpp v21, v21, v21 quad_perm:[2,3,0,1] row_mask:0xf bank_mask:0xf
    v_cmp_gt_f32 vcc, v21, v11
    s_cbranch_vccnz SLOWA_27
BACKA_28:
    v_fma_f32 v25, v21, v5, -v12
    v_exp_f32 v25, v25
    s_waitcnt vmcnt(19)
    buffer_load_dwordx4 v[148:151], v2, s[44:47], s65 offen offset:2048 nt
    v_add_f32 v13, v13, v25
    v_cvt_pk_bf16_f32 v26, v25, v25
    s_waitcnt vmcnt(19)
    buffer_load_dwordx4 v[152:155], v2, s[44:47], s65 offen offset:3072 nt
    v_and_b32_dpp v30, v26, v3 row_newbcast:0 row_mask:0xf bank_mask:0xf
    v_and_b32_dpp v31, v26, v4 row_newbcast:0 row_mask:0xf bank_mask:0xf
    v_and_b32_dpp v32, v26, v3 row_newbcast:4 row_mask:0xf bank_mask:0xf
    v_and_b32_dpp v33, v26, v4 row_newbcast:4 row_mask:0xf bank_mask:0xf
    v_and_b32_dpp v34, v26, v3 row_newbcast:8 row_mask:0xf bank_mask:0xf
    v_and_b32_dpp v35, v26, v4 row_newbcast:8 row_mask:0xf bank_mask:0xf
    v_and_b32_dpp v36, v26, v3 row_newbcast:12 row_mask:0xf bank_mask:0xf
    v_and_b32_dpp v37, v26, v4 row_newbcast:12 row_mask:0xf bank_mask:0xf
    s_nop 0
    v_mfma_f32_16x16x16_bf16 v[60:63], v[30:31], v[156:157], v[60:63]
    v_mfma_f32_16x16x16_bf16 v[64:67], v[30:31], v[158:159], v[64:67]
    s_waitcnt vmcnt(19)
    buffer_load_dwordx4 v[156:159], v2, s[48:51], s65 offen nt
    v_mfma_f32_16x16x16_bf16 v[60:63], v[32:33], v[160:161], v[60:63]
    v_mfma_f32_16x16x16_bf16 v[64:67], v[32:33], v[162:163], v[64:67]
    s_waitcnt vmcnt(19)
    buffer_load_dwordx4 v[160:163], v2, s[48:51], s65 offen offset:1024 nt
    v_mfma_f32_16x16x16_bf16 v[60:63], v[34:35], v[164:165], v[60:63]
    v_mfma_f32_16x16x16_bf16 v[64:67], v[34:35], v[166:167], v[64:67]
    s_waitcnt vmcnt(19)
    buffer_load_dwordx4 v[164:167], v2, s[48:51], s65 offen offset:2048 nt
    v_mfma_f32_16x16x16_bf16 v[60:63], v[36:37], v[168:169], v[60:63]
    v_mfma_f32_16x16x16_bf16 v[64:67], v[36:37], v[170:171], v[64:67]
    s_waitcnt vmcnt(19)
    buffer_load_dwordx4 v[168:171], v2, s[48:51], s65 offen offset:3072 nt
    v_dot2_f32_bf16 v17, v172, v40, 0
    v_dot2_f32_bf16 v18, v176, v40, 0
    v_dot2_f32_bf16 v19, v180, v40, 0
    v_dot2_f32_bf16 v20, v184, v40, 0
    v_dot2_f32_bf16 v17, v173, v41, v17
    v_dot2_f32_bf16 v18, v177, v41, v18
    v_dot2_f32_bf16 v19, v181, v41, v19
    v_dot2_f32_bf16 v20, v185, v41, v20
    v_dot2_f32_bf16 v17, v174, v42, v17
    v_dot2_f32_bf16 v18, v178, v42, v18
    v_dot2_f32_bf16 v19, v182, v42, v19
    v_dot2_f32_bf16 v20, v186, v42, v20
    v_dot2_f32_bf16 v17, v175, v43, v17
    v_dot2_f32_bf16 v18, v179, v43, v18
    v_dot2_f32_bf16 v19, v183, v43, v19
    v_dot2_f32_bf16 v20, v187, v43, v20
    s_waitcnt vmcnt(19)
    buffer_load_dwordx4 v[172:175], v2, s[44:47], s66 offen nt
    s_nop 0
    v_add_f32_dpp v17, v17, v17 row_ror:8 row_mask:0xf bank_mask:0x3
    v_add_f32_dpp v18, v18, v18 row_ror:8 row_mask:0xf bank_mask:0x3
    v_add_f32_dpp v17, v19, v19 row_ror:8 row_mask:0xf bank_mask:0xc
    v_add_f32_dpp v18, v20, v20 row_ror:8 row_mask:0xf bank_mask:0xc
    s_nop 1
    s_waitcnt vmcnt(19)
    buffer_load_dwordx4 v[176:179], v2, s[44:47], s66 offen offset:1024 nt
    v_add_f32_dpp v21, v17, v17 row_half_mirror row_mask:0xf bank_mask:0x5
    v_add_f32_dpp v21, v18, v18 row_half_mirror row_mask:0xf bank_mask:0xa
    s_nop 1
    v_add_f32_dpp v21, v21, v21 quad_perm:[1,0,3,2] row_mask:0xf bank_mask:0xf
    s_nop 1
    v_add_f32_dpp v21, v21, v21 quad_perm:[2,3,0,1] row_mask:0xf bank_mask:0xf
    v_cmp_gt_f32 vcc, v21, v11
    s_cbranch_vccnz SLOWA_29
BACKA_30:
    v_fma_f32 v25, v21, v5, -v12
    v_exp_f32 v25, v25
    s_waitcnt vmcnt(19)
    buffer_load_dwordx4 v[180:183], v2, s[44:47], s66 offen offset:2048 nt
    v_add_f32 v13, v13, v25
    v_cvt_pk_bf16_f32 v26, v25, v25
    s_waitcnt vmcnt(19)
    buffer_load_dwordx4 v[184:187], v2, s[44:47], s66 offen offset:3072 nt
    v_and_b32_dpp v30, v26, v3 row_newbcast:0 row_mask:0xf bank_mask:0xf
    v_and_b32_dpp v31, v26, v4 row_newbcast:0 row_mask:0xf bank_mask:0xf
    v_and_b32_dpp v32, v26, v3 row_newbcast:4 row_mask:0xf bank_mask:0xf
    v_and_b32_dpp v33, v26, v4 row_newbcast:4 row_mask:0xf bank_mask:0xf
    v_and_b32_dpp v34, v26, v3 row_newbcast:8 row_mask:0xf bank_mask:0xf
    v_and_b32_dpp v35, v26, v4 row_newbcast:8 row_mask:0xf bank_mask:0xf
    v_and_b32_dpp v36, v26, v3 row_newbcast:12 row_mask:0xf bank_mask:0xf
    v_and_b32_dpp v37, v26, v4 row_newbcast:12 row_mask:0xf bank_mask:0xf
    s_nop 0
    v_mfma_f32_16x16x16_bf16 v[60:63], v[30:31], v[188:189], v[60:63]
    v_mfma_f32_16x16x16_bf16 v[64:67], v[30:31], v[190:191], v[64:67]
    s_waitcnt vmcnt(19)
    buffer_load_dwordx4 v[188:191], v2, s[48:51], s66 offen nt
    v_mfma_f32_16x16x16_bf16 v[60:63], v[32:33], v[192:193], v[60:63]
    v_mfma_f32_16x16x16_bf16 v[64:67], v[32:33], v[194:195], v[64:67]
    s_waitcnt vmcnt(19)
    buffer_load_dwordx4 v[192:195], v2, s[48:51], s66 offen offset:1024 nt
    v_mfma_f32_16x16x16_bf16 v[60:63], v[34:35], v[196:197], v[60:63]
    v_mfma_f32_16x16x16_bf16 v[64:67], v[34:35], v[198:199], v[64:67]
    s_waitcnt vmcnt(19)
    buffer_load_dwordx4 v[196:199], v2, s[48:51], s66 offen offset:2048 nt
    v_mfma_f32_16x16x16_bf16 v[60:63], v[36:37], v[200:201], v[60:63]
    v_mfma_f32_16x16x16_bf16 v[64:67], v[36:37], v[202:203], v[64:67]
    s_waitcnt vmcnt(19)
    buffer_load_dwordx4 v[200:203], v2, s[48:51], s66 offen offset:3072 nt
    v_dot2_f32_bf16 v17, v204, v40, 0
    v_dot2_f32_bf16 v18, v208, v40, 0
    v_dot2_f32_bf16 v19, v212, v40, 0
    v_dot2_f32_bf16 v20, v216, v40, 0
    v_dot2_f32_bf16 v17, v205, v41, v17
    v_dot2_f32_bf16 v18, v209, v41, v18
    v_dot2_f32_bf16 v19, v213, v41, v19
    v_dot2_f32_bf16 v20, v217, v41, v20
    v_dot2_f32_bf16 v17, v206, v42, v17
    v_dot2_f32_bf16 v18, v210, v42, v18
    v_dot2_f32_bf16 v19, v214, v42, v19
    v_dot2_f32_bf16 v20, v218, v42, v20
    v_dot2_f32_bf16 v17, v207, v43, v17
    v_dot2_f32_bf16 v18, v211, v43, v18
    v_dot2_f32_bf16 v19, v215, v43, v19
    v_dot2_f32_bf16 v20, v219, v43, v20
    s_waitcnt vmcnt(19)
    buffer_load_dwordx4 v[204:207], v2, s[44:47], s67 offen nt
    s_nop 0
    v_add_f32_dpp v17, v17, v17 row_ror:8 row_mask:0xf bank_mask:0x3
    v_add_f32_dpp v18, v18, v18 row_ror:8 row_mask:0xf bank_mask:0x3
    v_add_f32_dpp v17, v19, v19 row_ror:8 row_mask:0xf bank_mask:0xc
    v_add_f32_dpp v18, v20, v20 row_ror:8 row_mask:0xf bank_mask:0xc
    s_nop 1
    s_waitcnt vmcnt(19)
    buffer_load_dwordx4 v[208:211], v2, s[44:47], s67 offen offset:1024 nt
    v_add_f32_dpp v21, v17, v17 row_half_mirror row_mask:0xf bank_mask:0x5
    v_add_f32_dpp v21, v18, v18 row_half_mirror row_mask:0xf bank_mask:0xa
    s_nop 1
    v_add_f32_dpp v21, v21, v21 quad_perm:[1,0,3,2] row_mask:0xf bank_mask:0xf
    s_nop 1
    v_add_f32_dpp v21, v21, v21 quad_perm:[2,3,0,1] row_mask:0xf bank_mask:0xf
    v_cmp_gt_f32 vcc, v21, v11
    s_cbranch_vccnz SLOWA_31
BACKA_32:
    v_fma_f32 v25, v21, v5, -v12
    v_exp_f32 v25, v25
    s_waitcnt vmcnt(19)
    buffer_load_dwordx4 v[212:215], v2, s[44:47], s67 offen offset:2048 nt
    v_add_f32 v13, v13, v25
    v_cvt_pk_bf16_f32 v26, v25, v25
    s_waitcnt vmcnt(19)
    buffer_load_dwordx4 v[216:219], v2, s[44:47], s67 offen offset:3072 nt
    v_and_b32_dpp v30, v26, v3 row_newbcast:0 row_mask:0xf bank_mask:0xf
    v_and_b32_dpp v31, v26, v4 row_newbcast:0 row_mask:0xf bank_mask:0xf
    v_and_b32_dpp v32, v26, v3 row_newbcast:4 row_mask:0xf bank_mask:0xf
    v_and_b32_dpp v33, v26, v4 row_newbcast:4 row_mask:0xf bank_mask:0xf
    v_and_b32_dpp v34, v26, v3 row_newbcast:8 row_mask:0xf bank_mask:0xf
    v_and_b32_dpp v35, v26, v4 row_newbcast:8 row_mask:0xf bank_mask:0xf
    v_and_b32_dpp v36, v26, v3 row_newbcast:12 row_mask:0xf bank_mask:0xf
    v_and_b32_dpp v37, v26, v4 row_newbcast:12 row_mask:0xf bank_mask:0xf
    s_nop 0
    v_mfma_f32_16x16x16_bf16 v[60:63], v[30:31], v[220:221], v[60:63]
    v_mfma_f32_16x16x16_bf16 v[64:67], v[30:31], v[222:223], v[64:67]
    s_waitcnt vmcnt(19)
    buffer_load_dwordx4 v[220:223], v2, s[48:51], s67 offen nt
    v_mfma_f32_16x16x16_bf16 v[60:63], v[32:33], v[224:225], v[60:63]
    v_mfma_f32_16x16x16_bf16 v[64:67], v[32:33], v[226:227], v[64:67]
    s_waitcnt vmcnt(19)
    buffer_load_dwordx4 v[224:227], v2, s[48:51], s67 offen offset:1024 nt
    v_mfma_f32_16x16x16_bf16 v[60:63], v[34:35], v[228:229], v[60:63]
    v_mfma_f32_16x16x16_bf16 v[64:67], v[34:35], v[230:231], v[64:67]
    s_waitcnt vmcnt(19)
    buffer_load_dwordx4 v[228:231], v2, s[48:51], s67 offen offset:2048 nt
    v_mfma_f32_16x16x16_bf16 v[60:63], v[36:37], v[232:233], v[60:63]
    v_mfma_f32_16x16x16_bf16 v[64:67], v[36:37], v[234:235], v[64:67]
    s_waitcnt vmcnt(19)
    buffer_load_dwordx4 v[232:235], v2, s[48:51], s67 offen offset:3072 nt
    s_cmp_lg_u32 s9, 20
    s_cbranch_scc1 LOOP_A2
LAST_A:
    s_waitcnt vmcnt(28)
    v_dot2_f32_bf16 v17, v108, v40, 0
    v_dot2_f32_bf16 v18, v112, v40, 0
    v_dot2_f32_bf16 v19, v116, v40, 0
    v_dot2_f32_bf16 v20, v120, v40, 0
    v_dot2_f32_bf16 v17, v109, v41, v17
    v_dot2_f32_bf16 v18, v113, v41, v18
    v_dot2_f32_bf16 v19, v117, v41, v19
    v_dot2_f32_bf16 v20, v121, v41, v20
    v_dot2_f32_bf16 v17, v110, v42, v17
    v_dot2_f32_bf16 v18, v114, v42, v18
    v_dot2_f32_bf16 v19, v118, v42, v19
    v_dot2_f32_bf16 v20, v122, v42, v20
    v_dot2_f32_bf16 v17, v111, v43, v17
    v_dot2_f32_bf16 v18, v115, v43, v18
    v_dot2_f32_bf16 v19, v119, v43, v19
    v_dot2_f32_bf16 v20, v123, v43, v20
    s_nop 1
    s_nop 0
    v_add_f32_dpp v17, v17, v17 row_ror:8 row_mask:0xf bank_mask:0x3
    v_add_f32_dpp v18, v18, v18 row_ror:8 row_mask:0xf bank_mask:0x3
    v_add_f32_dpp v17, v19, v19 row_ror:8 row_mask:0xf bank_mask:0xc
    v_add_f32_dpp v18, v20, v20 row_ror:8 row_mask:0xf bank_mask:0xc
    s_nop 1
    v_add_f32_dpp v21, v17, v17 row_half_mirror row_mask:0xf bank_mask:0x5
    v_add_f32_dpp v21, v18, v18 row_half_mirror row_mask:0xf bank_mask:0xa
    s_nop 1
    v_add_f32_dpp v21, v21, v21 quad_perm:[1,0,3,2] row_mask:0xf bank_mask:0xf
    s_nop 1
    v_add_f32_dpp v21, v21, v21 quad_perm:[2,3,0,1] row_mask:0xf bank_mask:0xf
    v_cmp_gt_f32 vcc, v21, v11
    s_cbranch_vccnz SLOWA_33
BACKA_34:
    v_fma_f32 v25, v21, v5, -v12
    v_exp_f32 v25, v25
    s_nop 1
    v_add_f32 v13, v13, v25
    v_cvt_pk_bf16_f32 v26, v25, v25
    s_nop 1
    v_and_b32_dpp v30, v26, v3 row_newbcast:0 row_mask:0xf bank_mask:0xf
    v_and_b32_dpp v31, v26, v4 row_newbcast:0 row_mask:0xf bank_mask:0xf
    v_and_b32_dpp v32, v26, v3 row_newbcast:4 row_mask:0xf bank_mask:0xf
    v_and_b32_dpp v33, v26, v4 row_newbcast:4 row_mask:0xf bank_mask:0xf
    v_and_b32_dpp v34, v26, v3 row_newbcast:8 row_mask:0xf bank_mask:0xf
    v_and_b32_dpp v35, v26, v4 row_newbcast:8 row_mask:0xf bank_mask:0xf
    v_and_b32_dpp v36, v26, v3 row_newbcast:12 row_mask:0xf bank_mask:0xf
    v_and_b32_dpp v37, v26, v4 row_newbcast:12 row_mask:0xf bank_mask:0xf
    s_nop 0
    s_waitcnt vmcnt(27)
    v_mfma_f32_16x16x16_bf16 v[60:63], v[30:31], v[124:125], v[60:63]
    v_mfma_f32_16x16x16_bf16 v[64:67], v[30:31], v[126:127], v[64:67]
    s_waitcnt vmcnt(26)
    v_mfma_f32_16x16x16_bf16 v[60:63], v[32:33], v[128:129], v[60:63]
    v_mfma_f32_16x16x16_bf16 v[64:67], v[32:33], v[130:131], v[64:67]
    s_waitcnt vmcnt(25)
    v_mfma_f32_16x16x16_bf16 v[60:63], v[34:35], v[132:133], v[60:63]
    v_mfma_f32_16x16x16_bf16 v[64:67], v[34:35], v[134:135], v[64:67]
    s_waitcnt vmcnt(24)
    v_mfma_f32_16x16x16_bf16 v[60:63], v[36:37], v[136:137], v[60:63]
    v_mfma_f32_16x16x16_bf16 v[64:67], v[36:37], v[138:139], v[64:67]
    s_waitcnt vmcnt(20)
    v_dot2_f32_bf16 v17, v140, v40, 0
    v_dot2_f32_bf16 v18, v144, v40, 0
    v_dot2_f32_bf16 v19, v148, v40, 0
    v_dot2_f32_bf16 v20, v152, v40, 0
    v_dot2_f32_bf16 v17, v141, v41, v17
    v_dot2_f32_bf16 v18, v145, v41, v18
    v_dot2_f32_bf16 v19, v149, v41, v19
    v_dot2_f32_bf16 v20, v153, v41, v20
    v_dot2_f32_bf16 v17, v142, v42, v17
    v_dot2_f32_bf16 v18, v146, v42, v18
    v_dot2_f32_bf16 v19, v150, v42, v19
    v_dot2_f32_bf16 v20, v154, v42, v20
    v_dot2_f32_bf16 v17, v143, v43, v17
    v_dot2_f32_bf16 v18, v147, v43, v18
    v_dot2_f32_bf16 v19, v151, v43, v19
    v_dot2_f32_bf16 v20, v155, v43, v20
    s_nop 1
    s_nop 0
    v_add_f32_dpp v17, v17, v17 row_ror:8 row_mask:0xf bank_mask:0x3
    v_add_f32_dpp v18, v18, v18 row_ror:8 row_mask:0xf bank_mask:0x3
    v_add_f32_dpp v17, v19, v19 row_ror:8 row_mask:0xf bank_mask:0xc
    v_add_f32_dpp v18, v20, v20 row_ror:8 row_mask:0xf bank_mask:0xc
    s_nop 1
    v_add_f32_dpp v21, v17, v17 row_half_mirror row_mask:0xf bank_mask:0x5
    v_add_f32_dpp v21, v18, v18 row_half_mirror row_mask:0xf bank_mask:0xa
    s_nop 1
    v_add_f32_dpp v21, v21, v21 quad_perm:[1,0,3,2] row_mask:0xf bank_mask:0xf
    s_nop 1
    v_add_f32_dpp v21, v21, v21 quad_perm:[2,3,0,1] row_mask:0xf bank_mask:0xf
    v_cmp_gt_f32 vcc, v21, v11
    s_cbranch_vccnz SLOWA_35
BACKA_36:
    v_fma_f32 v25, v21, v5, -v12
    v_exp_f32 v25, v25
    s_nop 1
    v_add_f32 v13, v13, v25
    v_cvt_pk_bf16_f32 v26, v25, v25
    s_nop 1
    v_and_b32_dpp v30, v26, v3 row_newbcast:0 row_mask:0xf bank_mask:0xf
    v_and_b32_dpp v31, v26, v4 row_newbcast:0 row_mask:0xf bank_mask:0xf
    v_and_b32_dpp v32, v26, v3 row_newbcast:4 row_mask:0xf bank_mask:0xf
    v_and_b32_dpp v33, v26, v4 row_newbcast:4 row_mask:0xf bank_mask:0xf
    v_and_b32_dpp v34, v26, v3 row_newbcast:8 row_mask:0xf bank_mask:0xf
    v_and_b32_dpp v35, v26, v4 row_newbcast:8 row_mask:0xf bank_mask:0xf
    v_and_b32_dpp v36, v26, v3 row_newbcast:12 row_mask:0xf bank_mask:0xf
    v_and_b32_dpp v37, v26, v4 row_newbcast:12 row_mask:0xf bank_mask:0xf
    s_nop 0
    s_waitcnt vmcnt(19)
    v_mfma_f32_16x16x16_bf16 v[60:63], v[30:31], v[156:157], v[60:63]
    v_mfma_f32_16x16x16_bf16 v[64:67], v[30:31], v[158:159], v[64:67]
    s_waitcnt vmcnt(18)
    v_mfma_f32_16x16x16_bf16 v[60:63], v[32:33], v[160:161], v[60:63]
    v_mfma_f32_16x16x16_bf16 v[64:67], v[32:33], v[162:163], v[64:67]
    s_waitcnt vmcnt(17)
    v_mfma_f32_16x16x16_bf16 v[60:63], v[34:35], v[164:165], v[60:63]
    v_mfma_f32_16x16x16_bf16 v[64:67], v[34:35], v[166:167], v[64:67]
    s_waitcnt vmcnt(16)
    v_mfma_f32_16x16x16_bf16 v[60:63], v[36:37], v[168:169], v[60:63]
    v_mfma_f32_16x16x16_bf16 v[64:67], v[36:37], v[170:171], v[64:67]
    s_waitcnt vmcnt(12)
    v_dot2_f32_bf16 v17, v172, v40, 0
    v_dot2_f32_bf16 v18, v176, v40, 0
    v_dot2_f32_bf16 v19, v180, v40, 0
    v_dot2_f32_bf16 v20, v184, v40, 0
    v_dot2_f32_bf16 v17, v173, v41, v17
    v_dot2_f32_bf16 v18, v177, v41, v18
    v_dot2_f32_bf16 v19, v181, v41, v19
    v_dot2_f32_bf16 v20, v185, v41, v20
    v_dot2_f32_bf16 v17, v174, v42, v17
    v_dot2_f32_bf16 v18, v178, v42, v18
    v_dot2_f32_bf16 v19, v182, v42, v19
    v_dot2_f32_bf16 v20, v186, v42, v20
    v_dot2_f32_bf16 v17, v175, v43, v17
    v_dot2_f32_bf16 v18, v179, v43, v18
    v_dot2_f32_bf16 v19, v183, v43, v19
    v_dot2_f32_bf16 v20, v187, v43, v20
    s_nop 1
    s_nop 0
    v_add_f32_dpp v17, v17, v17 row_ror:8 row_mask:0xf bank_mask:0x3
    v_add_f32_dpp v18, v18, v18 row_ror:8 row_mask:0xf bank_mask:0x3
    v_add_f32_dpp v17, v19, v19 row_ror:8 row_mask:0xf bank_mask:0xc
    v_add_f32_dpp v18, v20, v20 row_ror:8 row_mask:0xf bank_mask:0xc
    s_nop 1
    v_add_f32_dpp v21, v17, v17 row_half_mirror row_mask:0xf bank_mask:0x5
    v_add_f32_dpp v21, v18, v18 row_half_mirror row_mask:0xf bank_mask:0xa
    s_nop 1
    v_add_f32_dpp v21, v21, v21 quad_perm:[1,0,3,2] row_mask:0xf bank_mask:0xf
    s_nop 1
    v_add_f32_dpp v21, v21, v21 quad_perm:[2,3,0,1] row_mask:0xf bank_mask:0xf
    v_cmp_gt_f32 vcc, v21, v11
    s_cbranch_vccnz SLOWA_37
BACKA_38:
    v_fma_f32 v25, v21, v5, -v12
    v_exp_f32 v25, v25
    s_nop 1
    v_add_f32 v13, v13, v25
    v_cvt_pk_bf16_f32 v26, v25, v25
    s_nop 1
    v_and_b32_dpp v30, v26, v3 row_newbcast:0 row_mask:0xf bank_mask:0xf
    v_and_b32_dpp v31, v26, v4 row_newbcast:0 row_mask:0xf bank_mask:0xf
    v_and_b32_dpp v32, v26, v3 row_newbcast:4 row_mask:0xf bank_mask:0xf
    v_and_b32_dpp v33, v26, v4 row_newbcast:4 row_mask:0xf bank_mask:0xf
    v_and_b32_dpp v34, v26, v3 row_newbcast:8 row_mask:0xf bank_mask:0xf
    v_and_b32_dpp v35, v26, v4 row_newbcast:8 row_mask:0xf bank_mask:0xf
    v_and_b32_dpp v36, v26, v3 row_newbcast:12 row_mask:0xf bank_mask:0xf
    v_and_b32_dpp v37, v26, v4 row_newbcast:12 row_mask:0xf bank_mask:0xf
    s_nop 0
    s_waitcnt vmcnt(11)
    v_mfma_f32_16x16x16_bf16 v[60:63], v[30:31], v[188:189], v[60:63]
    v_mfma_f32_16x16x16_bf16 v[64:67], v[30:31], v[190:191], v[64:67]
    s_waitcnt vmcnt(10)
    v_mfma_f32_16x16x16_bf16 v[60:63], v[32:33], v[192:193], v[60:63]
    v_mfma_f32_16x16x16_bf16 v[64:67], v[32:33], v[194:195], v[64:67]
    s_waitcnt vmcnt(9)
    v_mfma_f32_16x16x16_bf16 v[60:63], v[34:35], v[196:197], v[60:63]
    v_mfma_f32_16x16x16_bf16 v[64:67], v[34:35], v[198:199], v[64:67]
    s_waitcnt vmcnt(8)
    v_mfma_f32_16x16x16_bf16 v[60:63], v[36:37], v[200:201], v[60:63]
    v_mfma_f32_16x16x16_bf16 v[64:67], v[36:37], v[202:203], v[64:67]
    s_waitcnt vmcnt(4)
    v_dot2_f32_bf16 v17, v204, v40, 0
    v_dot2_f32_bf16 v18, v208, v40, 0
    v_dot2_f32_bf16 v19, v212, v40, 0
    v_dot2_f32_bf16 v20, v216, v40, 0
    v_dot2_f32_bf16 v17, v205, v41, v17
    v_dot2_f32_bf16 v18, v209, v41, v18
    v_dot2_f32_bf16 v19, v213, v41, v19
    v_dot2_f32_bf16 v20, v217, v41, v20
    v_dot2_f32_bf16 v17, v206, v42, v17
    v_dot2_f32_bf16 v18, v210, v42, v18
    v_dot2_f32_bf16 v19, v214, v42, v19
    v_dot2_f32_bf16 v20, v218, v42, v20
    v_dot2_f32_bf16 v17, v207, v43, v17
    v_dot2_f32_bf16 v18, v211, v43, v18
    v_dot2_f32_bf16 v19, v215, v43, v19
    v_dot2_f32_bf16 v20, v219, v43, v20
    s_nop 1
    s_nop 0
    v_add_f32_dpp v17, v17, v17 row_ror:8 row_mask:0xf bank_mask:0x3
    v_add_f32_dpp v18, v18, v18 row_ror:8 row_mask:0xf bank_mask:0x3
    v_add_f32_dpp v17, v19, v19 row_ror:8 row_mask:0xf bank_mask:0xc
    v_add_f32_dpp v18, v20, v20 row_ror:8 row_mask:0xf bank_mask:0xc
    s_nop 1
    v_add_f32_dpp v21, v17, v17 row_half_mirror row_mask:0xf bank_mask:0x5
    v_add_f32_dpp v21, v18, v18 row_half_mirror row_mask:0xf bank_mask:0xa
    s_nop 1
    v_add_f32_dpp v21, v21, v21 quad_perm:[1,0,3,2] row_mask:0xf bank_mask:0xf
    s_nop 1
    v_add_f32_dpp v21, v21, v21 quad_perm:[2,3,0,1] row_mask:0xf bank_mask:0xf
    v_cmp_gt_f32 vcc, v21, v11
    s_cbranch_vccnz SLOWA_39
BACKA_40:
    v_fma_f32 v25, v21, v5, -v12
    v_exp_f32 v25, v25
    s_nop 1
    v_add_f32 v13, v13, v25
    v_cvt_pk_bf16_f32 v26, v25, v25
    s_nop 1
    v_and_b32_dpp v30, v26, v3 row_newbcast:0 row_mask:0xf bank_mask:0xf
    v_and_b32_dpp v31, v26, v4 row_newbcast:0 row_mask:0xf bank_mask:0xf
    v_and_b32_dpp v32, v26, v3 row_newbcast:4 row_mask:0xf bank_mask:0xf
    v_and_b32_dpp v33, v26, v4 row_newbcast:4 row_mask:0xf bank_mask:0xf
    v_and_b32_dpp v34, v26, v3 row_newbcast:8 row_mask:0xf bank_mask:0xf
    v_and_b32_dpp v35, v26, v4 row_newbcast:8 row_mask:0xf bank_mask:0xf
    v_and_b32_dpp v36, v26, v3 row_newbcast:12 row_mask:0xf bank_mask:0xf
    v_and_b32_dpp v37, v26, v4 row_newbcast:12 row_mask:0xf bank_mask:0xf
    s_nop 0
    s_waitcnt vmcnt(3)
    v_mfma_f32_16x16x16_bf16 v[60:63], v[30:31], v[220:221], v[60:63]
    v_mfma_f32_16x16x16_bf16 v[64:67], v[30:31], v[222:223], v[64:67]
    s_waitcnt vmcnt(2)
    v_mfma_f32_16x16x16_bf16 v[60:63], v[32:33], v[224:225], v[60:63]
    v_mfma_f32_16x16x16_bf16 v[64:67], v[32:33], v[226:227], v[64:67]
    s_waitcnt vmcnt(1)
    v_mfma_f32_16x16x16_bf16 v[60:63], v[34:35], v[228:229], v[60:63]
    v_mfma_f32_16x16x16_bf16 v[64:67], v[34:35], v[230:231], v[64:67]
    s_waitcnt vmcnt(0)
    v_mfma_f32_16x16x16_bf16 v[60:63], v[36:37], v[232:233], v[60:63]
    v_mfma_f32_16x16x16_bf16 v[64:67], v[36:37], v[234:235], v[64:67]
    v_add_f32_dpp v13, v13, v13 row_ror:4 row_mask:0xf bank_mask:0xf
    v_lshlrev_b32 v7, 5, v0
    s_lshl_b32 s10, s8, 9
    v_add_f32_dpp v13, v13, v13 row_ror:8 row_mask:0xf bank_mask:0xf
    v_add_u32 v7, s10, v7
    v_mov_b32 v8, v13
    s_nop 1
    v_permlane16_swap_b32 v13, v8
    s_nop 0
    v_add_f32 v13, v13, v8
    v_mov_b32 v8, v13
    s_nop 1
    v_permlane32_swap_b32 v13, v8
    s_nop 0
    v_add_f32 v13, v13, v8
    s_lshl_b32 s10, s8, 3
    v_mov_b32 v8, s10
    v_mov_b32 v32, v12
    v_mov_b32 v33, v13
    s_mov_b64 exec, 0xffff
    ds_write_b128 v7, v[60:63] offset:2048
    ds_write_b128 v7, v[64:67] offset:2064
    s_mov_b64 exec, 1
    ds_write_b64 v8, v[32:33] offset:4096
    s_mov_b64 exec, -1
    s_waitcnt lgkmcnt(0)
    s_barrier
    s_endpgm
SLOWA_1:
    v_max_f32_dpp v7, v21, v21 row_ror:4 row_mask:0xf bank_mask:0xf
    s_nop 1
    v_max_f32_dpp v7, v7, v7 row_ror:8 row_mask:0xf bank_mask:0xf
    v_mov_b32 v8, v7
    s_nop 1
    v_permlane16_swap_b32 v7, v8
    s_nop 0
    v_max_f32 v7, v7, v8
    v_mov_b32 v8, v7
    s_nop 1
    v_permlane32_swap_b32 v7, v8
    s_nop 0
    v_max_f32 v7, v7, v8
    v_max_f32 v11, v7, v11
    v_mul_f32 v9, v11, v5
    v_sub_f32 v8, v12, v9
    v_exp_f32 v8, v8
    v_mov_b32 v12, v9
    v_mul_f32 v13, v13, v8
    v_mul_f32 v60, v60, v8
    v_mul_f32 v61, v61, v8
    v_mul_f32 v62, v62, v8
    v_mul_f32 v63, v63, v8
    v_mul_f32 v64, v64, v8
    v_mul_f32 v65, v65, v8
    v_mul_f32 v66, v66, v8
    v_mul_f32 v67, v67, v8
    s_branch BACKA_2
SLOWA_3:
    v_max_f32_dpp v7, v21, v21 row_ror:4 row_mask:0xf bank_mask:0xf
    s_nop 1
    v_max_f32_dpp v7, v7, v7 row_ror:8 row_mask:0xf bank_mask:0xf
    v_mov_b32 v8, v7
    s_nop 1
    v_permlane16_swap_b32 v7, v8
    s_nop 0
    v_max_f32 v7, v7, v8
    v_mov_b32 v8, v7
    s_nop 1
    v_permlane32_swap_b32 v7, v8
    s_nop 0
    v_max_f32 v7, v7, v8
    v_max_f32 v11, v7, v11
    v_mul_f32 v9, v11, v5
    v_sub_f32 v8, v12, v9
    v_exp_f32 v8, v8
    v_mov_b32 v12, v9
    v_mul_f32 v13, v13, v8
    v_mul_f32 v60, v60, v8
    v_mul_f32 v61, v61, v8
    v_mul_f32 v62, v62, v8
    v_mul_f32 v63, v63, v8
    v_mul_f32 v64, v64, v8
    v_mul_f32 v65, v65, v8
    v_mul_f32 v66, v66, v8
    v_mul_f32 v67, v67, v8
    s_branch BACKA_4
SLOWA_5:
    v_max_f32_dpp v7, v21, v21 row_ror:4 row_mask:0xf bank_mask:0xf
    s_nop 1
    v_max_f32_dpp v7, v7, v7 row_ror:8 row_mask:0xf bank_mask:0xf
    v_mov_b32 v8, v7
    s_nop 1
    v_permlane16_swap_b32 v7, v8
    s_nop 0
    v_max_f32 v7, v7, v8
    v_mov_b32 v8, v7
    s_nop 1
    v_permlane32_swap_b32 v7, v8
    s_nop 0
    v_max_f32 v7, v7, v8
    v_max_f32 v11, v7, v11
    v_mul_f32 v9, v11, v5
    v_sub_f32 v8, v12, v9
    v_exp_f32 v8, v8
    v_mov_b32 v12, v9
    v_mul_f32 v13, v13, v8
    v_mul_f32 v60, v60, v8
    v_mul_f32 v61, v61, v8
    v_mul_f32 v62, v62, v8
    v_mul_f32 v63, v63, v8
    v_mul_f32 v64, v64, v8
    v_mul_f32 v65, v65, v8
    v_mul_f32 v66, v66, v8
    v_mul_f32 v67, v67, v8
    s_branch BACKA_6
SLOWA_7:
    v_max_f32_dpp v7, v21, v21 row_ror:4 row_mask:0xf bank_mask:0xf
    s_nop 1
    v_max_f32_dpp v7, v7, v7 row_ror:8 row_mask:0xf bank_mask:0xf
    v_mov_b32 v8, v7
    s_nop 1
    v_permlane16_swap_b32 v7, v8
    s_nop 0
    v_max_f32 v7, v7, v8
    v_mov_b32 v8, v7
    s_nop 1
    v_permlane32_swap_b32 v7, v8
    s_nop 0
    v_max_f32 v7, v7, v8
    v_max_f32 v11, v7, v11
    v_mul_f32 v9, v11, v5
    v_sub_f32 v8, v12, v9
    v_exp_f32 v8, v8
    v_mov_b32 v12, v9
    v_mul_f32 v13, v13, v8
    v_mul_f32 v60, v60, v8
    v_mul_f32 v61, v61, v8
    v_mul_f32 v62, v62, v8
    v_mul_f32 v63, v63, v8
    v_mul_f32 v64, v64, v8
    v_mul_f32 v65, v65, v8
    v_mul_f32 v66, v66, v8
    v_mul_f32 v67, v67, v8
    s_branch BACKA_8
SLOWA_9:
    v_max_f32_dpp v7, v21, v21 row_ror:4 row_mask:0xf bank_mask:0xf
    s_nop 1
    v_max_f32_dpp v7, v7, v7 row_ror:8 row_mask:0xf bank_mask:0xf
    v_mov_b32 v8, v7
    s_nop 1
    v_permlane16_swap_b32 v7, v8
    s_nop 0
    v_max_f32 v7, v7, v8
    v_mov_b32 v8, v7
    s_nop 1
    v_permlane32_swap_b32 v7, v8
    s_nop 0
    v_max_f32 v7, v7, v8
    v_max_f32 v11, v7, v11
    v_mul_f32 v9, v11, v5
    v_sub_f32 v8, v12, v9
    v_exp_f32 v8, v8
    v_mov_b32 v12, v9
    v_mul_f32 v13, v13, v8
    v_mul_f32 v60, v60, v8
    v_mul_f32 v61, v61, v8
    v_mul_f32 v62, v62, v8
    v_mul_f32 v63, v63, v8
    v_mul_f32 v64, v64, v8
    v_mul_f32 v65, v65, v8
    v_mul_f32 v66, v66, v8
    v_mul_f32 v67, v67, v8
    s_branch BACKA_10
SLOWA_11:
    v_max_f32_dpp v7, v21, v21 row_ror:4 row_mask:0xf bank_mask:0xf
    s_nop 1
    v_max_f32_dpp v7, v7, v7 row_ror:8 row_mask:0xf bank_mask:0xf
    v_mov_b32 v8, v7
    s_nop 1
    v_permlane16_swap_b32 v7, v8
    s_nop 0
    v_max_f32 v7, v7, v8
    v_mov_b32 v8, v7
    s_nop 1
    v_permlane32_swap_b32 v7, v8
    s_nop 0
    v_max_f32 v7, v7, v8
    v_max_f32 v11, v7, v11
    v_mul_f32 v9, v11, v5
    v_sub_f32 v8, v12, v9
    v_exp_f32 v8, v8
    v_mov_b32 v12, v9
    v_mul_f32 v13, v13, v8
    v_mul_f32 v60, v60, v8
    v_mul_f32 v61, v61, v8
    v_mul_f32 v62, v62, v8
    v_mul_f32 v63, v63, v8
    v_mul_f32 v64, v64, v8
    v_mul_f32 v65, v65, v8
    v_mul_f32 v66, v66, v8
    v_mul_f32 v67, v67, v8
    s_branch BACKA_12
SLOWA_13:
    v_max_f32_dpp v7, v21, v21 row_ror:4 row_mask:0xf bank_mask:0xf
    s_nop 1
    v_max_f32_dpp v7, v7, v7 row_ror:8 row_mask:0xf bank_mask:0xf
    v_mov_b32 v8, v7
    s_nop 1
    v_permlane16_swap_b32 v7, v8
    s_nop 0
    v_max_f32 v7, v7, v8
    v_mov_b32 v8, v7
    s_nop 1
    v_permlane32_swap_b32 v7, v8
    s_nop 0
    v_max_f32 v7, v7, v8
    v_max_f32 v11, v7, v11
    v_mul_f32 v9, v11, v5
    v_sub_f32 v8, v12, v9
    v_exp_f32 v8, v8
    v_mov_b32 v12, v9
    v_mul_f32 v13, v13, v8
    v_mul_f32 v60, v60, v8
    v_mul_f32 v61, v61, v8
    v_mul_f32 v62, v62, v8
    v_mul_f32 v63, v63, v8
    v_mul_f32 v64, v64, v8
    v_mul_f32 v65, v65, v8
    v_mul_f32 v66, v66, v8
    v_mul_f32 v67, v67, v8
    s_branch BACKA_14
SLOWA_15:
    v_max_f32_dpp v7, v21, v21 row_ror:4 row_mask:0xf bank_mask:0xf
    s_nop 1
    v_max_f32_dpp v7, v7, v7 row_ror:8 row_mask:0xf bank_mask:0xf
    v_mov_b32 v8, v7
    s_nop 1
    v_permlane16_swap_b32 v7, v8
    s_nop 0
    v_max_f32 v7, v7, v8
    v_mov_b32 v8, v7
    s_nop 1
    v_permlane32_swap_b32 v7, v8
    s_nop 0
    v_max_f32 v7, v7, v8
    v_max_f32 v11, v7, v11
    v_mul_f32 v9, v11, v5
    v_sub_f32 v8, v12, v9
    v_exp_f32 v8, v8
    v_mov_b32 v12, v9
    v_mul_f32 v13, v13, v8
    v_mul_f32 v60, v60, v8
    v_mul_f32 v61, v61, v8
    v_mul_f32 v62, v62, v8
    v_mul_f32 v63, v63, v8
    v_mul_f32 v64, v64, v8
    v_mul_f32 v65, v65, v8
    v_mul_f32 v66, v66, v8
    v_mul_f32 v67, v67, v8
    s_branch BACKA_16
SLOWA_17:
    v_max_f32_dpp v7, v21, v21 row_ror:4 row_mask:0xf bank_mask:0xf
    s_nop 1
    v_max_f32_dpp v7, v7, v7 row_ror:8 row_mask:0xf bank_mask:0xf
    v_mov_b32 v8, v7
    s_nop 1
    v_permlane16_swap_b32 v7, v8
    s_nop 0
    v_max_f32 v7, v7, v8
    v_mov_b32 v8, v7
    s_nop 1
    v_permlane32_swap_b32 v7, v8
    s_nop 0
    v_max_f32 v7, v7, v8
    v_max_f32 v11, v7, v11
    v_mul_f32 v9, v11, v5
    v_sub_f32 v8, v12, v9
    v_exp_f32 v8, v8
    v_mov_b32 v12, v9
    v_mul_f32 v13, v13, v8
    v_mul_f32 v60, v60, v8
    v_mul_f32 v61, v61, v8
    v_mul_f32 v62, v62, v8
    v_mul_f32 v63, v63, v8
    v_mul_f32 v64, v64, v8
    v_mul_f32 v65, v65, v8
    v_mul_f32 v66, v66, v8
    v_mul_f32 v67, v67, v8
    s_branch BACKA_18
SLOWA_19:
    v_max_f32_dpp v7, v21, v21 row_ror:4 row_mask:0xf bank_mask:0xf
    s_nop 1
    v_max_f32_dpp v7, v7, v7 row_ror:8 row_mask:0xf bank_mask:0xf
    v_mov_b32 v8, v7
    s_nop 1
    v_permlane16_swap_b32 v7, v8
    s_nop 0
    v_max_f32 v7, v7, v8
    v_mov_b32 v8, v7
    s_nop 1
    v_permlane32_swap_b32 v7, v8
    s_nop 0
    v_max_f32 v7, v7, v8
    v_max_f32 v11, v7, v11
    v_mul_f32 v9, v11, v5
    v_sub_f32 v8, v12, v9
    v_exp_f32 v8, v8
    v_mov_b32 v12, v9
    v_mul_f32 v13, v13, v8
    v_mul_f32 v60, v60, v8
    v_mul_f32 v61, v61, v8
    v_mul_f32 v62, v62, v8
    v_mul_f32 v63, v63, v8
    v_mul_f32 v64, v64, v8
    v_mul_f32 v65, v65, v8
    v_mul_f32 v66, v66, v8
    v_mul_f32 v67, v67, v8
    s_branch BACKA_20
SLOWA_21:
    v_max_f32_dpp v7, v21, v21 row_ror:4 row_mask:0xf bank_mask:0xf
    s_nop 1
    v_max_f32_dpp v7, v7, v7 row_ror:8 row_mask:0xf bank_mask:0xf
    v_mov_b32 v8, v7
    s_nop 1
    v_permlane16_swap_b32 v7, v8
    s_nop 0
    v_max_f32 v7, v7, v8
    v_mov_b32 v8, v7
    s_nop 1
    v_permlane32_swap_b32 v7, v8
    s_nop 0
    v_max_f32 v7, v7, v8
    v_max_f32 v11, v7, v11
    v_mul_f32 v9, v11, v5
    v_sub_f32 v8, v12, v9
    v_exp_f32 v8, v8
    v_mov_b32 v12, v9
    v_mul_f32 v13, v13, v8
    v_mul_f32 v60, v60, v8
    v_mul_f32 v61, v61, v8
    v_mul_f32 v62, v62, v8
    v_mul_f32 v63, v63, v8
    v_mul_f32 v64, v64, v8
    v_mul_f32 v65, v65, v8
    v_mul_f32 v66, v66, v8
    v_mul_f32 v67, v67, v8
    s_branch BACKA_22
SLOWA_23:
    v_max_f32_dpp v7, v21, v21 row_ror:4 row_mask:0xf bank_mask:0xf
    s_nop 1
    v_max_f32_dpp v7, v7, v7 row_ror:8 row_mask:0xf bank_mask:0xf
    v_mov_b32 v8, v7
    s_nop 1
    v_permlane16_swap_b32 v7, v8
    s_nop 0
    v_max_f32 v7, v7, v8
    v_mov_b32 v8, v7
    s_nop 1
    v_permlane32_swap_b32 v7, v8
    s_nop 0
    v_max_f32 v7, v7, v8
    v_max_f32 v11, v7, v11
    v_mul_f32 v9, v11, v5
    v_sub_f32 v8, v12, v9
    v_exp_f32 v8, v8
    v_mov_b32 v12, v9
    v_mul_f32 v13, v13, v8
    v_mul_f32 v60, v60, v8
    v_mul_f32 v61, v61, v8
    v_mul_f32 v62, v62, v8
    v_mul_f32 v63, v63, v8
    v_mul_f32 v64, v64, v8
    v_mul_f32 v65, v65, v8
    v_mul_f32 v66, v66, v8
    v_mul_f32 v67, v67, v8
    s_branch BACKA_24
SLOWA_25:
    v_max_f32_dpp v7, v21, v21 row_ror:4 row_mask:0xf bank_mask:0xf
    s_nop 1
    v_max_f32_dpp v7, v7, v7 row_ror:8 row_mask:0xf bank_mask:0xf
    v_mov_b32 v8, v7
    s_nop 1
    v_permlane16_swap_b32 v7, v8
    s_nop 0
    v_max_f32 v7, v7, v8
    v_mov_b32 v8, v7
    s_nop 1
    v_permlane32_swap_b32 v7, v8
    s_nop 0
    v_max_f32 v7, v7, v8
    v_max_f32 v11, v7, v11
    v_mul_f32 v9, v11, v5
    v_sub_f32 v8, v12, v9
    v_exp_f32 v8, v8
    v_mov_b32 v12, v9
    v_mul_f32 v13, v13, v8
    v_mul_f32 v60, v60, v8
    v_mul_f32 v61, v61, v8
    v_mul_f32 v62, v62, v8
    v_mul_f32 v63, v63, v8
    v_mul_f32 v64, v64, v8
    v_mul_f32 v65, v65, v8
    v_mul_f32 v66, v66, v8
    v_mul_f32 v67, v67, v8
    s_branch BACKA_26
SLOWA_27:
    v_max_f32_dpp v7, v21, v21 row_ror:4 row_mask:0xf bank_mask:0xf
    s_nop 1
    v_max_f32_dpp v7, v7, v7 row_ror:8 row_mask:0xf bank_mask:0xf
    v_mov_b32 v8, v7
    s_nop 1
    v_permlane16_swap_b32 v7, v8
    s_nop 0
    v_max_f32 v7, v7, v8
    v_mov_b32 v8, v7
    s_nop 1
    v_permlane32_swap_b32 v7, v8
    s_nop 0
    v_max_f32 v7, v7, v8
    v_max_f32 v11, v7, v11
    v_mul_f32 v9, v11, v5
    v_sub_f32 v8, v12, v9
    v_exp_f32 v8, v8
    v_mov_b32 v12, v9
    v_mul_f32 v13, v13, v8
    v_mul_f32 v60, v60, v8
    v_mul_f32 v61, v61, v8
    v_mul_f32 v62, v62, v8
    v_mul_f32 v63, v63, v8
    v_mul_f32 v64, v64, v8
    v_mul_f32 v65, v65, v8
    v_mul_f32 v66, v66, v8
    v_mul_f32 v67, v67, v8
    s_branch BACKA_28
SLOWA_29:
    v_max_f32_dpp v7, v21, v21 row_ror:4 row_mask:0xf bank_mask:0xf
    s_nop 1
    v_max_f32_dpp v7, v7, v7 row_ror:8 row_mask:0xf bank_mask:0xf
    v_mov_b32 v8, v7
    s_nop 1
    v_permlane16_swap_b32 v7, v8
    s_nop 0
    v_max_f32 v7, v7, v8
    v_mov_b32 v8, v7
    s_nop 1
    v_permlane32_swap_b32 v7, v8
    s_nop 0
    v_max_f32 v7, v7, v8
    v_max_f32 v11, v7, v11
    v_mul_f32 v9, v11, v5
    v_sub_f32 v8, v12, v9
    v_exp_f32 v8, v8
    v_mov_b32 v12, v9
    v_mul_f32 v13, v13, v8
    v_mul_f32 v60, v60, v8
    v_mul_f32 v61, v61, v8
    v_mul_f32 v62, v62, v8
    v_mul_f32 v63, v63, v8
    v_mul_f32 v64, v64, v8
    v_mul_f32 v65, v65, v8
    v_mul_f32 v66, v66, v8
    v_mul_f32 v67, v67, v8
    s_branch BACKA_30
SLOWA_31:
    v_max_f32_dpp v7, v21, v21 row_ror:4 row_mask:0xf bank_mask:0xf
    s_nop 1
    v_max_f32_dpp v7, v7, v7 row_ror:8 row_mask:0xf bank_mask:0xf
    v_mov_b32 v8, v7
    s_nop 1
    v_permlane16_swap_b32 v7, v8
    s_nop 0
    v_max_f32 v7, v7, v8
    v_mov_b32 v8, v7
    s_nop 1
    v_permlane32_swap_b32 v7, v8
    s_nop 0
    v_max_f32 v7, v7, v8
    v_max_f32 v11, v7, v11
    v_mul_f32 v9, v11, v5
    v_sub_f32 v8, v12, v9
    v_exp_f32 v8, v8
    v_mov_b32 v12, v9
    v_mul_f32 v13, v13, v8
    v_mul_f32 v60, v60, v8
    v_mul_f32 v61, v61, v8
    v_mul_f32 v62, v62, v8
    v_mul_f32 v63, v63, v8
    v_mul_f32 v64, v64, v8
    v_mul_f32 v65, v65, v8
    v_mul_f32 v66, v66, v8
    v_mul_f32 v67, v67, v8
    s_branch BACKA_32
SLOWA_33:
    v_max_f32_dpp v7, v21, v21 row_ror:4 row_mask:0xf bank_mask:0xf
    s_nop 1
    v_max_f32_dpp v7, v7, v7 row_ror:8 row_mask:0xf bank_mask:0xf
    v_mov_b32 v8, v7
    s_nop 1
    v_permlane16_swap_b32 v7, v8
    s_nop 0
    v_max_f32 v7, v7, v8
    v_mov_b32 v8, v7
    s_nop 1
    v_permlane32_swap_b32 v7, v8
    s_nop 0
    v_max_f32 v7, v7, v8
    v_max_f32 v11, v7, v11
    v_mul_f32 v9, v11, v5
    v_sub_f32 v8, v12, v9
    v_exp_f32 v8, v8
    v_mov_b32 v12, v9
    v_mul_f32 v13, v13, v8
    v_mul_f32 v60, v60, v8
    v_mul_f32 v61, v61, v8
    v_mul_f32 v62, v62, v8
    v_mul_f32 v63, v63, v8
    v_mul_f32 v64, v64, v8
    v_mul_f32 v65, v65, v8
    v_mul_f32 v66, v66, v8
    v_mul_f32 v67, v67, v8
    s_branch BACKA_34
SLOWA_35:
    v_max_f32_dpp v7, v21, v21 row_ror:4 row_mask:0xf bank_mask:0xf
    s_nop 1
    v_max_f32_dpp v7, v7, v7 row_ror:8 row_mask:0xf bank_mask:0xf
    v_mov_b32 v8, v7
    s_nop 1
    v_permlane16_swap_b32 v7, v8
    s_nop 0
    v_max_f32 v7, v7, v8
    v_mov_b32 v8, v7
    s_nop 1
    v_permlane32_swap_b32 v7, v8
    s_nop 0
    v_max_f32 v7, v7, v8
    v_max_f32 v11, v7, v11
    v_mul_f32 v9, v11, v5
    v_sub_f32 v8, v12, v9
    v_exp_f32 v8, v8
    v_mov_b32 v12, v9
    v_mul_f32 v13, v13, v8
    v_mul_f32 v60, v60, v8
    v_mul_f32 v61, v61, v8
    v_mul_f32 v62, v62, v8
    v_mul_f32 v63, v63, v8
    v_mul_f32 v64, v64, v8
    v_mul_f32 v65, v65, v8
    v_mul_f32 v66, v66, v8
    v_mul_f32 v67, v67, v8
    s_branch BACKA_36
SLOWA_37:
    v_max_f32_dpp v7, v21, v21 row_ror:4 row_mask:0xf bank_mask:0xf
    s_nop 1
    v_max_f32_dpp v7, v7, v7 row_ror:8 row_mask:0xf bank_mask:0xf
    v_mov_b32 v8, v7
    s_nop 1
    v_permlane16_swap_b32 v7, v8
    s_nop 0
    v_max_f32 v7, v7, v8
    v_mov_b32 v8, v7
    s_nop 1
    v_permlane32_swap_b32 v7, v8
    s_nop 0
    v_max_f32 v7, v7, v8
    v_max_f32 v11, v7, v11
    v_mul_f32 v9, v11, v5
    v_sub_f32 v8, v12, v9
    v_exp_f32 v8, v8
    v_mov_b32 v12, v9
    v_mul_f32 v13, v13, v8
    v_mul_f32 v60, v60, v8
    v_mul_f32 v61, v61, v8
    v_mul_f32 v62, v62, v8
    v_mul_f32 v63, v63, v8
    v_mul_f32 v64, v64, v8
    v_mul_f32 v65, v65, v8
    v_mul_f32 v66, v66, v8
    v_mul_f32 v67, v67, v8
    s_branch BACKA_38
SLOWA_39:
    v_max_f32_dpp v7, v21, v21 row_ror:4 row_mask:0xf bank_mask:0xf
    s_nop 1
    v_max_f32_dpp v7, v7, v7 row_ror:8 row_mask:0xf bank_mask:0xf
    v_mov_b32 v8, v7
    s_nop 1
    v_permlane16_swap_b32 v7, v8
    s_nop 0
    v_max_f32 v7, v7, v8
    v_mov_b32 v8, v7
    s_nop 1
    v_permlane32_swap_b32 v7, v8
    s_nop 0
    v_max_f32 v7, v7, v8
    v_max_f32 v11, v7, v11
    v_mul_f32 v9, v11, v5
    v_sub_f32 v8, v12, v9
    v_exp_f32 v8, v8
    v_mov_b32 v12, v9
    v_mul_f32 v13, v13, v8
    v_mul_f32 v60, v60, v8
    v_mul_f32 v61, v61, v8
    v_mul_f32 v62, v62, v8
    v_mul_f32 v63, v63, v8
    v_mul_f32 v64, v64, v8
    v_mul_f32 v65, v65, v8
    v_mul_f32 v66, v66, v8
    v_mul_f32 v67, v67, v8
    s_branch BACKA_40
PHASE_B:
    v_mov_b32 v8, 0
    s_mov_b32 s12, 0
LW_41:
    ds_read_b32 v7, v8 offset:4160
    s_waitcnt lgkmcnt(0)
    v_readfirstlane_b32 s10, v7
    s_cmp_eq_u32 s10, 1
    s_cbranch_scc1 LWD_42
    s_add_u32 s12, s12, 1
    s_cmp_gt_u32 s12, 4194304
    s_cbranch_scc1 DONE
    s_sleep 1
    s_branch LW_41
LWD_42:
    v_and_b32 v9, 15, v0
    v_lshlrev_b32 v9, 4, v9
    ds_read_b128 v[44:47], v9 offset:4352
    ds_read_b128 v[48:51], v9 offset:4608
    ds_read_b128 v[52:55], v9 offset:4864
    ds_read_b128 v[56:59], v9 offset:5120
    s_waitcnt lgkmcnt(0)
LOOP_B:
    s_sub_u32 s10, s9, 7
    s_cmp_lt_u32 s10, 4
    s_cselect_b64 s[44:45], s[60:61], s[56:57]
    s_cselect_b64 s[48:49], s[62:63], s[58:59]
    s_mov_b32 s11, 0x100000
    s_cselect_b32 s46, 0x40000, s11
    s_mov_b32 s50, s46
    s_cselect_b32 s10, s10, s9
    s_sub_u32 s11, s9, 4
    s_cmp_ge_u32 s9, 11
    s_cselect_b32 s10, s11, s10
    s_lshl_b32 s64, s10, 16
    s_add_u32 s65, s64, 16384
    s_add_u32 s66, s64, 32768
    s_add_u32 s67, s64, 49152
    s_add_u32 s9, s9, 1
    v_dot2_f32_bf16 v17, v108, v44, 0
    v_dot2_f32_bf16 v18, v108, v48, 0
    v_dot2_f32_bf16 v19, v108, v52, 0
    v_dot2_f32_bf16 v20, v108, v56, 0
    v_dot2_f32_bf16 v17, v109, v45, v17
    v_dot2_f32_bf16 v18, v109, v49, v18
    v_dot2_f32_bf16 v19, v109, v53, v19
    v_dot2_f32_bf16 v20, v109, v57, v20
    v_dot2_f32_bf16 v17, v110, v46, v17
    v_dot2_f32_bf16 v18, v110, v50, v18
    v_dot2_f32_bf16 v19, v110, v54, v19
    v_dot2_f32_bf16 v20, v110, v58, v20
    v_dot2_f32_bf16 v17, v111, v47, v17
    v_dot2_f32_bf16 v18, v111, v51, v18
    v_dot2_f32_bf16 v19, v111, v55, v19
    v_dot2_f32_bf16 v20, v111, v59, v20
    s_waitcnt vmcnt(5)
    buffer_load_dwordx4 v[108:111], v2, s[44:47], s64 offen nt
    s_nop 0
    v_add_f32_dpp v17, v17, v17 row_ror:8 row_mask:0xf bank_mask:0x3
    v_add_f32_dpp v18, v18, v18 row_ror:8 row_mask:0xf bank_mask:0x3
    v_add_f32_dpp v17, v19, v19 row_ror:8 row_mask:0xf bank_mask:0xc
    v_add_f32_dpp v18, v20, v20 row_ror:8 row_mask:0xf bank_mask:0xc
    s_nop 1
    v_add_f32_dpp v21, v17, v17 row_half_mirror row_mask:0xf bank_mask:0x5
    v_add_f32_dpp v21, v18, v18 row_half_mirror row_mask:0xf bank_mask:0xa
    s_nop 1
    v_add_f32_dpp v21, v21, v21 quad_perm:[1,0,3,2] row_mask:0xf bank_mask:0xf
    s_nop 1
    v_add_f32_dpp v21, v21, v21 quad_perm:[2,3,0,1] row_mask:0xf bank_mask:0xf
    v_dot2_f32_bf16 v17, v112, v44, 0
    v_dot2_f32_bf16 v18, v112, v48, 0
    v_dot2_f32_bf16 v19, v112, v52, 0
    v_dot2_f32_bf16 v20, v112, v56, 0
    v_dot2_f32_bf16 v17, v113, v45, v17
    v_dot2_f32_bf16 v18, v113, v49, v18
    v_dot2_f32_bf16 v19, v113, v53, v19
    v_dot2_f32_bf16 v20, v113, v57, v20
    v_dot2_f32_bf16 v17, v114, v46, v17
    v_dot2_f32_bf16 v18, v114, v50, v18
    v_dot2_f32_bf16 v19, v114, v54, v19
    v_dot2_f32_bf16 v20, v114, v58, v20
    v_dot2_f32_bf16 v17, v115, v47, v17
    v_dot2_f32_bf16 v18, v115, v51, v18
    v_dot2_f32_bf16 v19, v115, v55, v19
    v_dot2_f32_bf16 v20, v115, v59, v20
    s_waitcnt vmcnt(5)
    buffer_load_dwordx4 v[112:115], v2, s[44:47], s64 offen offset:1024 nt
    s_nop 0
    v_add_f32_dpp v17, v17, v17 row_ror:8 row_mask:0xf bank_mask:0x3
    v_add_f32_dpp v18, v18, v18 row_ror:8 row_mask:0xf bank_mask:0x3
    v_add_f32_dpp v17, v19, v19 row_ror:8 row_mask:0xf bank_mask:0xc
    v_add_f32_dpp v18, v20, v20 row_ror:8 row_mask:0xf bank_mask:0xc
    s_nop 1
    v_add_f32_dpp v22, v17, v17 row_half_mirror row_mask:0xf bank_mask:0x5
    v_add_f32_dpp v22, v18, v18 row_half_mirror row_mask:0xf bank_mask:0xa
    s_nop 1
    v_add_f32_dpp v22, v22, v22 quad_perm:[1,0,3,2] row_mask:0xf bank_mask:0xf
    s_nop 1
    v_add_f32_dpp v22, v22, v22 quad_perm:[2,3,0,1] row_mask:0xf bank_mask:0xf
    v_dot2_f32_bf16 v17, v116, v44, 0
    v_dot2_f32_bf16 v18, v116, v48, 0
    v_dot2_f32_bf16 v19, v116, v52, 0
    v_dot2_f32_bf16 v20, v116, v56, 0
    v_dot2_f32_bf16 v17, v117, v45, v17
    v_dot2_f32_bf16 v18, v117, v49, v18
    v_dot2_f32_bf16 v19, v117, v53, v19
    v_dot2_f32_bf16 v20, v117, v57, v20
    v_dot2_f32_bf16 v17, v118, v46, v17
    v_dot2_f32_bf16 v18, v118, v50, v18
    v_dot2_f32_bf16 v19, v118, v54, v19
    v_dot2_f32_bf16 v20, v118, v58, v20
    v_dot2_f32_bf16 v17, v119, v47, v17
    v_dot2_f32_bf16 v18, v119, v51, v18
    v_dot2_f32_bf16 v19, v119, v55, v19
    v_dot2_f32_bf16 v20, v119, v59, v20
    s_waitcnt vmcnt(5)
    buffer_load_dwordx4 v[116:119], v2, s[44:47], s64 offen offset:2048 nt
    s_nop 0
    v_add_f32_dpp v17, v17, v17 row_ror:8 row_mask:0xf bank_mask:0x3
    v_add_f32_dpp v18, v18, v18 row_ror:8 row_mask:0xf bank_mask:0x3
    v_add_f32_dpp v17, v19, v19 row_ror:8 row_mask:0xf bank_mask:0xc
    v_add_f32_dpp v18, v20, v20 row_ror:8 row_mask:0xf bank_mask:0xc
    s_nop 1
    v_add_f32_dpp v23, v17, v17 row_half_mirror row_mask:0xf bank_mask:0x5
    v_add_f32_dpp v23, v18, v18 row_half_mirror row_mask:0xf bank_mask:0xa
    s_nop 1
    v_add_f32_dpp v23, v23, v23 quad_perm:[1,0,3,2] row_mask:0xf bank_mask:0xf
    s_nop 1
    v_add_f32_dpp v23, v23, v23 quad_perm:[2,3,0,1] row_mask:0xf bank_mask:0xf
    v_dot2_f32_bf16 v17, v120, v44, 0
    v_dot2_f32_bf16 v18, v120, v48, 0
    v_dot2_f32_bf16 v19, v120, v52, 0
    v_dot2_f32_bf16 v20, v120, v56, 0
    v_dot2_f32_bf16 v17, v121, v45, v17
    v_dot2_f32_bf16 v18, v121, v49, v18
    v_dot2_f32_bf16 v19, v121, v53, v19
    v_dot2_f32_bf16 v20, v121, v57, v20
    v_dot2_f32_bf16 v17, v122, v46, v17
    v_dot2_f32_bf16 v18, v122, v50, v18
    v_dot2_f32_bf16 v19, v122, v54, v19
    v_dot2_f32_bf16 v20, v122, v58, v20
    v_dot2_f32_bf16 v17, v123, v47, v17
    v_dot2_f32_bf16 v18, v123, v51, v18
    v_dot2_f32_bf16 v19, v123, v55, v19
    v_dot2_f32_bf16 v20, v123, v59, v20
    s_waitcnt vmcnt(5)
    buffer_load_dwordx4 v[120:123], v2, s[44:47], s64 offen offset:3072 nt
    s_nop 0
    v_add_f32_dpp v17, v17, v17 row_ror:8 row_mask:0xf bank_mask:0x3
    v_add_f32_dpp v18, v18, v18 row_ror:8 row_mask:0xf bank_mask:0x3
    v_add_f32_dpp v17, v19, v19 row_ror:8 row_mask:0xf bank_mask:0xc
    v_add_f32_dpp v18, v20, v20 row_ror:8 row_mask:0xf bank_mask:0xc
    s_nop 1
    v_add_f32_dpp v24, v17, v17 row_half_mirror row_mask:0xf bank_mask:0x5
    v_add_f32_dpp v24, v18, v18 row_half_mirror row_mask:0xf bank_mask:0xa
    s_nop 1
    v_add_f32_dpp v24, v24, v24 quad_perm:[1,0,3,2] row_mask:0xf bank_mask:0xf
    s_nop 1
    v_add_f32_dpp v24, v24, v24 quad_perm:[2,3,0,1] row_mask:0xf bank_mask:0xf
    v_max3_f32 v7, v21, v22, v23
    v_max_f32 v7, v7, v24
    v_cmp_gt_f32 vcc, v7, v14
    s_cbranch_vccnz SLOWB_43
BACKB_44:
    v_fma_f32 v25, v21, v5, -v15
    v_fma_f32 v26, v22, v5, -v15
    v_fma_f32 v27, v23, v5, -v15
    v_fma_f32 v28, v24, v5, -v15
    v_exp_f32 v25, v25
    v_exp_f32 v26, v26
    v_exp_f32 v27, v27
    v_exp_f32 v28, v28
    s_nop 0
    v_add_f32 v16, v16, v25
    v_cvt_pk_bf16_f32 v25, v25, v25
    v_add_f32 v16, v16, v26
    v_cvt_pk_bf16_f32 v26, v26, v26
    v_add_f32 v16, v16, v27
    v_cvt_pk_bf16_f32 v27, v27, v27
    v_add_f32 v16, v16, v28
    v_cvt_pk_bf16_f32 v28, v28, v28
    v_and_b32 v30, v25, v3
    v_and_b32 v31, v25, v4
    v_and_b32 v32, v26, v3
    v_and_b32 v33, v26, v4
    v_and_b32 v34, v27, v3
    v_and_b32 v35, v27, v4
    v_and_b32 v36, v28, v3
    v_and_b32 v37, v28, v4
    s_nop 0
    v_mfma_f32_16x16x16_bf16 v[68:71], v[30:31], v[124:125], v[68:71]
    v_mfma_f32_16x16x16_bf16 v[72:75], v[30:31], v[126:127], v[72:75]
    s_waitcnt vmcnt(5)
    buffer_load_dwordx4 v[124:127], v2, s[48:51], s64 offen nt
    v_mfma_f32_16x16x16_bf16 v[68:71], v[32:33], v[128:129], v[68:71]
    v_mfma_f32_16x16x16_bf16 v[72:75], v[32:33], v[130:131], v[72:75]
    s_waitcnt vmcnt(5)
    buffer_load_dwordx4 v[128:131], v2, s[48:51], s64 offen offset:1024 nt
    v_mfma_f32_16x16x16_bf16 v[68:71], v[34:35], v[132:133], v[68:71]
    v_mfma_f32_16x16x16_bf16 v[72:75], v[34:35], v[134:135], v[72:75]
    s_waitcnt vmcnt(5)
    buffer_load_dwordx4 v[132:135], v2, s[48:51], s64 offen offset:2048 nt
    v_mfma_f32_16x16x16_bf16 v[68:71], v[36:37], v[136:137], v[68:71]
    v_mfma_f32_16x16x16_bf16 v[72:75], v[36:37], v[138:139], v[72:75]
    s_waitcnt vmcnt(5)
    buffer_load_dwordx4 v[136:139], v2, s[48:51], s64 offen offset:3072 nt
    v_dot2_f32_bf16 v17, v140, v44, 0
    v_dot2_f32_bf16 v18, v140, v48, 0
    v_dot2_f32_bf16 v19, v140, v52, 0
    v_dot2_f32_bf16 v20, v140, v56, 0
    v_dot2_f32_bf16 v17, v141, v45, v17
    v_dot2_f32_bf16 v18, v141, v49, v18
    v_dot2_f32_bf16 v19, v141, v53, v19
    v_dot2_f32_bf16 v20, v141, v57, v20
    v_dot2_f32_bf16 v17, v142, v46, v17
    v_dot2_f32_bf16 v18, v142, v50, v18
    v_dot2_f32_bf16 v19, v142, v54, v19
    v_dot2_f32_bf16 v20, v142, v58, v20
    v_dot2_f32_bf16 v17, v143, v47, v17
    v_dot2_f32_bf16 v18, v143, v51, v18
    v_dot2_f32_bf16 v19, v143, v55, v19
    v_dot2_f32_bf16 v20, v143, v59, v20
    s_waitcnt vmcnt(5)
    buffer_load_dwordx4 v[140:143], v2, s[44:47], s65 offen nt
    s_nop 0
    v_add_f32_dpp v17, v17, v17 row_ror:8 row_mask:0xf bank_mask:0x3
    v_add_f32_dpp v18, v18, v18 row_ror:8 row_mask:0xf bank_mask:0x3
    v_add_f32_dpp v17, v19, v19 row_ror:8 row_mask:0xf bank_mask:0xc
    v_add_f32_dpp v18, v20, v20 row_ror:8 row_mask:0xf bank_mask:0xc
    s_nop 1
    v_add_f32_dpp v21, v17, v17 row_half_mirror row_mask:0xf bank_mask:0x5
    v_add_f32_dpp v21, v18, v18 row_half_mirror row_mask:0xf bank_mask:0xa
    s_nop 1
    v_add_f32_dpp v21, v21, v21 quad_perm:[1,0,3,2] row_mask:0xf bank_mask:0xf
    s_nop 1
    v_add_f32_dpp v21, v21, v21 quad_perm:[2,3,0,1] row_mask:0xf bank_mask:0xf
    v_dot2_f32_bf16 v17, v144, v44, 0
    v_dot2_f32_bf16 v18, v144, v48, 0
    v_dot2_f32_bf16 v19, v144, v52, 0
    v_dot2_f32_bf16 v20, v144, v56, 0
    v_dot2_f32_bf16 v17, v145, v45, v17
    v_dot2_f32_bf16 v18, v145, v49, v18
    v_dot2_f32_bf16 v19, v145, v53, v19
    v_dot2_f32_bf16 v20, v145, v57, v20
    v_dot2_f32_bf16 v17, v146, v46, v17
    v_dot2_f32_bf16 v18, v146, v50, v18
    v_dot2_f32_bf16 v19, v146, v54, v19
    v_dot2_f32_bf16 v20, v146, v58, v20
    v_dot2_f32_bf16 v17, v147, v47, v17
    v_dot2_f32_bf16 v18, v147, v51, v18
    v_dot2_f32_bf16 v19, v147, v55, v19
    v_dot2_f32_bf16 v20, v147, v59, v20
    s_waitcnt vmcnt(5)
    buffer_load_dwordx4 v[144:147], v2, s[44:47], s65 offen offset:1024 nt
    s_nop 0
    v_add_f32_dpp v17, v17, v17 row_ror:8 row_mask:0xf bank_mask:0x3
    v_add_f32_dpp v18, v18, v18 row_ror:8 row_mask:0xf bank_mask:0x3
    v_add_f32_dpp v17, v19, v19 row_ror:8 row_mask:0xf bank_mask:0xc
    v_add_f32_dpp v18, v20, v20 row_ror:8 row_mask:0xf bank_mask:0xc
    s_nop 1
    v_add_f32_dpp v22, v17, v17 row_half_mirror row_mask:0xf bank_mask:0x5
    v_add_f32_dpp v22, v18, v18 row_half_mirror row_mask:0xf bank_mask:0xa
    s_nop 1
    v_add_f32_dpp v22, v22, v22 quad_perm:[1,0,3,2] row_mask:0xf bank_mask:0xf
    s_nop 1
    v_add_f32_dpp v22, v22, v22 quad_perm:[2,3,0,1] row_mask:0xf bank_mask:0xf
    v_dot2_f32_bf16 v17, v148, v44, 0
    v_dot2_f32_bf16 v18, v148, v48, 0
    v_dot2_f32_bf16 v19, v148, v52, 0
    v_dot2_f32_bf16 v20, v148, v56, 0
    v_dot2_f32_bf16 v17, v149, v45, v17
    v_dot2_f32_bf16 v18, v149, v49, v18
    v_dot2_f32_bf16 v19, v149, v53, v19
    v_dot2_f32_bf16 v20, v149, v57, v20
    v_dot2_f32_bf16 v17, v150, v46, v17
    v_dot2_f32_bf16 v18, v150, v50, v18
    v_dot2_f32_bf16 v19, v150, v54, v19
    v_dot2_f32_bf16 v20, v150, v58, v20
    v_dot2_f32_bf16 v17, v151, v47, v17
    v_dot2_f32_bf16 v18, v151, v51, v18
    v_dot2_f32_bf16 v19, v151, v55, v19
    v_dot2_f32_bf16 v20, v151, v59, v20
    s_waitcnt vmcnt(5)
    buffer_load_dwordx4 v[148:151], v2, s[44:47], s65 offen offset:2048 nt
    s_nop 0
    v_add_f32_dpp v17, v17, v17 row_ror:8 row_mask:0xf bank_mask:0x3
    v_add_f32_dpp v18, v18, v18 row_ror:8 row_mask:0xf bank_mask:0x3
    v_add_f32_dpp v17, v19, v19 row_ror:8 row_mask:0xf bank_mask:0xc
    v_add_f32_dpp v18, v20, v20 row_ror:8 row_mask:0xf bank_mask:0xc
    s_nop 1
    v_add_f32_dpp v23, v17, v17 row_half_mirror row_mask:0xf bank_mask:0x5
    v_add_f32_dpp v23, v18, v18 row_half_mirror row_mask:0xf bank_mask:0xa
    s_nop 1
    v_add_f32_dpp v23, v23, v23 quad_perm:[1,0,3,2] row_mask:0xf bank_mask:0xf
    s_nop 1
    v_add_f32_dpp v23, v23, v23 quad_perm:[2,3,0,1] row_mask:0xf bank_mask:0xf
    v_dot2_f32_bf16 v17, v152, v44, 0
    v_dot2_f32_bf16 v18, v152, v48, 0
    v_dot2_f32_bf16 v19, v152, v52, 0
    v_dot2_f32_bf16 v20, v152, v56, 0
    v_dot2_f32_bf16 v17, v153, v45, v17
    v_dot2_f32_bf16 v18, v153, v49, v18
    v_dot2_f32_bf16 v19, v153, v53, v19
    v_dot2_f32_bf16 v20, v153, v57, v20
    v_dot2_f32_bf16 v17, v154, v46, v17
    v_dot2_f32_bf16 v18, v154, v50, v18
    v_dot2_f32_bf16 v19, v154, v54, v19
    v_dot2_f32_bf16 v20, v154, v58, v20
    v_dot2_f32_bf16 v17, v155, v47, v17
    v_dot2_f32_bf16 v18, v155, v51, v18
    v_dot2_f32_bf16 v19, v155, v55, v19
    v_dot2_f32_bf16 v20, v155, v59, v20
    s_waitcnt vmcnt(5)
    buffer_load_dwordx4 v[152:155], v2, s[44:47], s65 offen offset:3072 nt
    s_nop 0
    v_add_f32_dpp v17, v17, v17 row_ror:8 row_mask:0xf bank_mask:0x3
    v_add_f32_dpp v18, v18, v18 row_ror:8 row_mask:0xf bank_mask:0x3
    v_add_f32_dpp v17, v19, v19 row_ror:8 row_mask:0xf bank_mask:0xc
    v_add_f32_dpp v18, v20, v20 row_ror:8 row_mask:0xf bank_mask:0xc
    s_nop 1
    v_add_f32_dpp v24, v17, v17 row_half_mirror row_mask:0xf bank_mask:0x5
    v_add_f32_dpp v24, v18, v18 row_half_mirror row_mask:0xf bank_mask:0xa
    s_nop 1
    v_add_f32_dpp v24, v24, v24 quad_perm:[1,0,3,2] row_mask:0xf bank_mask:0xf
    s_nop 1
    v_add_f32_dpp v24, v24, v24 quad_perm:[2,3,0,1] row_mask:0xf bank_mask:0xf
    v_max3_f32 v7, v21, v22, v23
    v_max_f32 v7, v7, v24
    v_cmp_gt_f32 vcc, v7, v14
    s_cbranch_vccnz SLOWB_45
BACKB_46:
    v_fma_f32 v25, v21, v5, -v15
    v_fma_f32 v26, v22, v5, -v15
    v_fma_f32 v27, v23, v5, -v15
    v_fma_f32 v28, v24, v5, -v15
    v_exp_f32 v25, v25
    v_exp_f32 v26, v26
    v_exp_f32 v27, v27
    v_exp_f32 v28, v28
    s_nop 0
    v_add_f32 v16, v16, v25
    v_cvt_pk_bf16_f32 v25, v25, v25
    v_add_f32 v16, v16, v26
    v_cvt_pk_bf16_f32 v26, v26, v26
    v_add_f32 v16, v16, v27
    v_cvt_pk_bf16_f32 v27, v27, v27
    v_add_f32 v16, v16, v28
    v_cvt_pk_bf16_f32 v28, v28, v28
    v_and_b32 v30, v25, v3
    v_and_b32 v31, v25, v4
    v_and_b32 v32, v26, v3
    v_and_b32 v33, v26, v4
    v_and_b32 v34, v27, v3
    v_and_b32 v35, v27, v4
    v_and_b32 v36, v28, v3
    v_and_b32 v37, v28, v4
    s_nop 0
    v_mfma_f32_16x16x16_bf16 v[68:71], v[30:31], v[156:157], v[68:71]
    v_mfma_f32_16x16x16_bf16 v[72:75], v[30:31], v[158:159], v[72:75]
    s_waitcnt vmcnt(5)
    buffer_load_dwordx4 v[156:159], v2, s[48:51], s65 offen nt
    v_mfma_f32_16x16x16_bf16 v[68:71], v[32:33], v[160:161], v[68:71]
    v_mfma_f32_16x16x16_bf16 v[72:75], v[32:33], v[162:163], v[72:75]
    s_waitcnt vmcnt(5)
    buffer_load_dwordx4 v[160:163], v2, s[48:51], s65 offen offset:1024 nt
    v_mfma_f32_16x16x16_bf16 v[68:71], v[34:35], v[164:165], v[68:71]
    v_mfma_f32_16x16x16_bf16 v[72:75], v[34:35], v[166:167], v[72:75]
    s_waitcnt vmcnt(5)
    buffer_load_dwordx4 v[164:167], v2, s[48:51], s65 offen offset:2048 nt
    v_mfma_f32_16x16x16_bf16 v[68:71], v[36:37], v[168:169], v[68:71]
    v_mfma_f32_16x16x16_bf16 v[72:75], v[36:37], v[170:171], v[72:75]
    s_waitcnt vmcnt(5)
    buffer_load_dwordx4 v[168:171], v2, s[48:51], s65 offen offset:3072 nt
    v_dot2_f32_bf16 v17, v172, v44, 0
    v_dot2_f32_bf16 v18, v172, v48, 0
    v_dot2_f32_bf16 v19, v172, v52, 0
    v_dot2_f32_bf16 v20, v172, v56, 0
    v_dot2_f32_bf16 v17, v173, v45, v17
    v_dot2_f32_bf16 v18, v173, v49, v18
    v_dot2_f32_bf16 v19, v173, v53, v19
    v_dot2_f32_bf16 v20, v173, v57, v20
    v_dot2_f32_bf16 v17, v174, v46, v17
    v_dot2_f32_bf16 v18, v174, v50, v18
    v_dot2_f32_bf16 v19, v174, v54, v19
    v_dot2_f32_bf16 v20, v174, v58, v20
    v_dot2_f32_bf16 v17, v175, v47, v17
    v_dot2_f32_bf16 v18, v175, v51, v18
    v_dot2_f32_bf16 v19, v175, v55, v19
    v_dot2_f32_bf16 v20, v175, v59, v20
    s_waitcnt vmcnt(5)
    buffer_load_dwordx4 v[172:175], v2, s[44:47], s66 offen nt
    s_nop 0
    v_add_f32_dpp v17, v17, v17 row_ror:8 row_mask:0xf bank_mask:0x3
    v_add_f32_dpp v18, v18, v18 row_ror:8 row_mask:0xf bank_mask:0x3
    v_add_f32_dpp v17, v19, v19 row_ror:8 row_mask:0xf bank_mask:0xc
    v_add_f32_dpp v18, v20, v20 row_ror:8 row_mask:0xf bank_mask:0xc
    s_nop 1
    v_add_f32_dpp v21, v17, v17 row_half_mirror row_mask:0xf bank_mask:0x5
    v_add_f32_dpp v21, v18, v18 row_half_mirror row_mask:0xf bank_mask:0xa
    s_nop 1
    v_add_f32_dpp v21, v21, v21 quad_perm:[1,0,3,2] row_mask:0xf bank_mask:0xf
    s_nop 1
    v_add_f32_dpp v21, v21, v21 quad_perm:[2,3,0,1] row_mask:0xf bank_mask:0xf
    v_dot2_f32_bf16 v17, v176, v44, 0
    v_dot2_f32_bf16 v18, v176, v48, 0
    v_dot2_f32_bf16 v19, v176, v52, 0
    v_dot2_f32_bf16 v20, v176, v56, 0
    v_dot2_f32_bf16 v17, v177, v45, v17
    v_dot2_f32_bf16 v18, v177, v49, v18
    v_dot2_f32_bf16 v19, v177, v53, v19
    v_dot2_f32_bf16 v20, v177, v57, v20
    v_dot2_f32_bf16 v17, v178, v46, v17
    v_dot2_f32_bf16 v18, v178, v50, v18
    v_dot2_f32_bf16 v19, v178, v54, v19
    v_dot2_f32_bf16 v20, v178, v58, v20
    v_dot2_f32_bf16 v17, v179, v47, v17
    v_dot2_f32_bf16 v18, v179, v51, v18
    v_dot2_f32_bf16 v19, v179, v55, v19
    v_dot2_f32_bf16 v20, v179, v59, v20
    s_waitcnt vmcnt(5)
    buffer_load_dwordx4 v[176:179], v2, s[44:47], s66 offen offset:1024 nt
    s_nop 0
    v_add_f32_dpp v17, v17, v17 row_ror:8 row_mask:0xf bank_mask:0x3
    v_add_f32_dpp v18, v18, v18 row_ror:8 row_mask:0xf bank_mask:0x3
    v_add_f32_dpp v17, v19, v19 row_ror:8 row_mask:0xf bank_mask:0xc
    v_add_f32_dpp v18, v20, v20 row_ror:8 row_mask:0xf bank_mask:0xc
    s_nop 1
    v_add_f32_dpp v22, v17, v17 row_half_mirror row_mask:0xf bank_mask:0x5
    v_add_f32_dpp v22, v18, v18 row_half_mirror row_mask:0xf bank_mask:0xa
    s_nop 1
    v_add_f32_dpp v22, v22, v22 quad_perm:[1,0,3,2] row_mask:0xf bank_mask:0xf
    s_nop 1
    v_add_f32_dpp v22, v22, v22 quad_perm:[2,3,0,1] row_mask:0xf bank_mask:0xf
    v_dot2_f32_bf16 v17, v180, v44, 0
    v_dot2_f32_bf16 v18, v180, v48, 0
    v_dot2_f32_bf16 v19, v180, v52, 0
    v_dot2_f32_bf16 v20, v180, v56, 0
    v_dot2_f32_bf16 v17, v181, v45, v17
    v_dot2_f32_bf16 v18, v181, v49, v18
    v_dot2_f32_bf16 v19, v181, v53, v19
    v_dot2_f32_bf16 v20, v181, v57, v20
    v_dot2_f32_bf16 v17, v182, v46, v17
    v_dot2_f32_bf16 v18, v182, v50, v18
    v_dot2_f32_bf16 v19, v182, v54, v19
    v_dot2_f32_bf16 v20, v182, v58, v20
    v_dot2_f32_bf16 v17, v183, v47, v17
    v_dot2_f32_bf16 v18, v183, v51, v18
    v_dot2_f32_bf16 v19, v183, v55, v19
    v_dot2_f32_bf16 v20, v183, v59, v20
    s_waitcnt vmcnt(5)
    buffer_load_dwordx4 v[180:183], v2, s[44:47], s66 offen offset:2048 nt
    s_nop 0
    v_add_f32_dpp v17, v17, v17 row_ror:8 row_mask:0xf bank_mask:0x3
    v_add_f32_dpp v18, v18, v18 row_ror:8 row_mask:0xf bank_mask:0x3
    v_add_f32_dpp v17, v19, v19 row_ror:8 row_mask:0xf bank_mask:0xc
    v_add_f32_dpp v18, v20, v20 row_ror:8 row_mask:0xf bank_mask:0xc
    s_nop 1
    v_add_f32_dpp v23, v17, v17 row_half_mirror row_mask:0xf bank_mask:0x5
    v_add_f32_dpp v23, v18, v18 row_half_mirror row_mask:0xf bank_mask:0xa
    s_nop 1
    v_add_f32_dpp v23, v23, v23 quad_perm:[1,0,3,2] row_mask:0xf bank_mask:0xf
    s_nop 1
    v_add_f32_dpp v23, v23, v23 quad_perm:[2,3,0,1] row_mask:0xf bank_mask:0xf
    v_dot2_f32_bf16 v17, v184, v44, 0
    v_dot2_f32_bf16 v18, v184, v48, 0
    v_dot2_f32_bf16 v19, v184, v52, 0
    v_dot2_f32_bf16 v20, v184, v56, 0
    v_dot2_f32_bf16 v17, v185, v45, v17
    v_dot2_f32_bf16 v18, v185, v49, v18
    v_dot2_f32_bf16 v19, v185, v53, v19
    v_dot2_f32_bf16 v20, v185, v57, v20
    v_dot2_f32_bf16 v17, v186, v46, v17
    v_dot2_f32_bf16 v18, v186, v50, v18
    v_dot2_f32_bf16 v19, v186, v54, v19
    v_dot2_f32_bf16 v20, v186, v58, v20
    v_dot2_f32_bf16 v17, v187, v47, v17
    v_dot2_f32_bf16 v18, v187, v51, v18
    v_dot2_f32_bf16 v19, v187, v55, v19
    v_dot2_f32_bf16 v20, v187, v59, v20
    s_waitcnt vmcnt(5)
    buffer_load_dwordx4 v[184:187], v2, s[44:47], s66 offen offset:3072 nt
    s_nop 0
    v_add_f32_dpp v17, v17, v17 row_ror:8 row_mask:0xf bank_mask:0x3
    v_add_f32_dpp v18, v18, v18 row_ror:8 row_mask:0xf bank_mask:0x3
    v_add_f32_dpp v17, v19, v19 row_ror:8 row_mask:0xf bank_mask:0xc
    v_add_f32_dpp v18, v20, v20 row_ror:8 row_mask:0xf bank_mask:0xc
    s_nop 1
    v_add_f32_dpp v24, v17, v17 row_half_mirror row_mask:0xf bank_mask:0x5
    v_add_f32_dpp v24, v18, v18 row_half_mirror row_mask:0xf bank_mask:0xa
    s_nop 1
    v_add_f32_dpp v24, v24, v24 quad_perm:[1,0,3,2] row_mask:0xf bank_mask:0xf
    s_nop 1
    v_add_f32_dpp v24, v24, v24 quad_perm:[2,3,0,1] row_mask:0xf bank_mask:0xf
    v_max3_f32 v7, v21, v22, v23
    v_max_f32 v7, v7, v24
    v_cmp_gt_f32 vcc, v7, v14
    s_cbranch_vccnz SLOWB_47
BACKB_48:
    v_fma_f32 v25, v21, v5, -v15
    v_fma_f32 v26, v22, v5, -v15
    v_fma_f32 v27, v23, v5, -v15
    v_fma_f32 v28, v24, v5, -v15
    v_exp_f32 v25, v25
    v_exp_f32 v26, v26
    v_exp_f32 v27, v27
    v_exp_f32 v28, v28
    s_nop 0
    v_add_f32 v16, v16, v25
    v_cvt_pk_bf16_f32 v25, v25, v25
    v_add_f32 v16, v16, v26
    v_cvt_pk_bf16_f32 v26, v26, v26
    v_add_f32 v16, v16, v27
    v_cvt_pk_bf16_f32 v27, v27, v27
    v_add_f32 v16, v16, v28
    v_cvt_pk_bf16_f32 v28, v28, v28
    v_and_b32 v30, v25, v3
    v_and_b32 v31, v25, v4
    v_and_b32 v32, v26, v3
    v_and_b32 v33, v26, v4
    v_and_b32 v34, v27, v3
    v_and_b32 v35, v27, v4
    v_and_b32 v36, v28, v3
    v_and_b32 v37, v28, v4
    s_nop 0
    v_mfma_f32_16x16x16_bf16 v[68:71], v[30:31], v[188:189], v[68:71]
    v_mfma_f32_16x16x16_bf16 v[72:75], v[30:31], v[190:191], v[72:75]
    s_waitcnt vmcnt(5)
    buffer_load_dwordx4 v[188:191], v2, s[48:51], s66 offen nt
    v_mfma_f32_16x16x16_bf16 v[68:71], v[32:33], v[192:193], v[68:71]
    v_mfma_f32_16x16x16_bf16 v[72:75], v[32:33], v[194:195], v[72:75]
    s_waitcnt vmcnt(5)
    buffer_load_dwordx4 v[192:195], v2, s[48:51], s66 offen offset:1024 nt
    v_mfma_f32_16x16x16_bf16 v[68:71], v[34:35], v[196:197], v[68:71]
    v_mfma_f32_16x16x16_bf16 v[72:75], v[34:35], v[198:199], v[72:75]
    s_waitcnt vmcnt(5)
    buffer_load_dwordx4 v[196:199], v2, s[48:51], s66 offen offset:2048 nt
    v_mfma_f32_16x16x16_bf16 v[68:71], v[36:37], v[200:201], v[68:71]
    v_mfma_f32_16x16x16_bf16 v[72:75], v[36:37], v[202:203], v[72:75]
    s_waitcnt vmcnt(5)
    buffer_load_dwordx4 v[200:203], v2, s[48:51], s66 offen offset:3072 nt
    v_dot2_f32_bf16 v17, v204, v44, 0
    v_dot2_f32_bf16 v18, v204, v48, 0
    v_dot2_f32_bf16 v19, v204, v52, 0
    v_dot2_f32_bf16 v20, v204, v56, 0
    v_dot2_f32_bf16 v17, v205, v45, v17
    v_dot2_f32_bf16 v18, v205, v49, v18
    v_dot2_f32_bf16 v19, v205, v53, v19
    v_dot2_f32_bf16 v20, v205, v57, v20
    v_dot2_f32_bf16 v17, v206, v46, v17
    v_dot2_f32_bf16 v18, v206, v50, v18
    v_dot2_f32_bf16 v19, v206, v54, v19
    v_dot2_f32_bf16 v20, v206, v58, v20
    v_dot2_f32_bf16 v17, v207, v47, v17
    v_dot2_f32_bf16 v18, v207, v51, v18
    v_dot2_f32_bf16 v19, v207, v55, v19
    v_dot2_f32_bf16 v20, v207, v59, v20
    s_waitcnt vmcnt(5)
    buffer_load_dwordx4 v[204:207], v2, s[44:47], s67 offen nt
    s_nop 0
    v_add_f32_dpp v17, v17, v17 row_ror:8 row_mask:0xf bank_mask:0x3
    v_add_f32_dpp v18, v18, v18 row_ror:8 row_mask:0xf bank_mask:0x3
    v_add_f32_dpp v17, v19, v19 row_ror:8 row_mask:0xf bank_mask:0xc
    v_add_f32_dpp v18, v20, v20 row_ror:8 row_mask:0xf bank_mask:0xc
    s_nop 1
    v_add_f32_dpp v21, v17, v17 row_half_mirror row_mask:0xf bank_mask:0x5
    v_add_f32_dpp v21, v18, v18 row_half_mirror row_mask:0xf bank_mask:0xa
    s_nop 1
    v_add_f32_dpp v21, v21, v21 quad_perm:[1,0,3,2] row_mask:0xf bank_mask:0xf
    s_nop 1
    v_add_f32_dpp v21, v21, v21 quad_perm:[2,3,0,1] row_mask:0xf bank_mask:0xf
    v_dot2_f32_bf16 v17, v208, v44, 0
    v_dot2_f32_bf16 v18, v208, v48, 0
    v_dot2_f32_bf16 v19, v208, v52, 0
    v_dot2_f32_bf16 v20, v208, v56, 0
    v_dot2_f32_bf16 v17, v209, v45, v17
    v_dot2_f32_bf16 v18, v209, v49, v18
    v_dot2_f32_bf16 v19, v209, v53, v19
    v_dot2_f32_bf16 v20, v209, v57, v20
    v_dot2_f32_bf16 v17, v210, v46, v17
    v_dot2_f32_bf16 v18, v210, v50, v18
    v_dot2_f32_bf16 v19, v210, v54, v19
    v_dot2_f32_bf16 v20, v210, v58, v20
    v_dot2_f32_bf16 v17, v211, v47, v17
    v_dot2_f32_bf16 v18, v211, v51, v18
    v_dot2_f32_bf16 v19, v211, v55, v19
    v_dot2_f32_bf16 v20, v211, v59, v20
    s_waitcnt vmcnt(5)
    buffer_load_dwordx4 v[208:211], v2, s[44:47], s67 offen offset:1024 nt
    s_nop 0
    v_add_f32_dpp v17, v17, v17 row_ror:8 row_mask:0xf bank_mask:0x3
    v_add_f32_dpp v18, v18, v18 row_ror:8 row_mask:0xf bank_mask:0x3
    v_add_f32_dpp v17, v19, v19 row_ror:8 row_mask:0xf bank_mask:0xc
    v_add_f32_dpp v18, v20, v20 row_ror:8 row_mask:0xf bank_mask:0xc
    s_nop 1
    v_add_f32_dpp v22, v17, v17 row_half_mirror row_mask:0xf bank_mask:0x5
    v_add_f32_dpp v22, v18, v18 row_half_mirror row_mask:0xf bank_mask:0xa
    s_nop 1
    v_add_f32_dpp v22, v22, v22 quad_perm:[1,0,3,2] row_mask:0xf bank_mask:0xf
    s_nop 1
    v_add_f32_dpp v22, v22, v22 quad_perm:[2,3,0,1] row_mask:0xf bank_mask:0xf
    v_dot2_f32_bf16 v17, v212, v44, 0
    v_dot2_f32_bf16 v18, v212, v48, 0
    v_dot2_f32_bf16 v19, v212, v52, 0
    v_dot2_f32_bf16 v20, v212, v56, 0
    v_dot2_f32_bf16 v17, v213, v45, v17
    v_dot2_f32_bf16 v18, v213, v49, v18
    v_dot2_f32_bf16 v19, v213, v53, v19
    v_dot2_f32_bf16 v20, v213, v57, v20
    v_dot2_f32_bf16 v17, v214, v46, v17
    v_dot2_f32_bf16 v18, v214, v50, v18
    v_dot2_f32_bf16 v19, v214, v54, v19
    v_dot2_f32_bf16 v20, v214, v58, v20
    v_dot2_f32_bf16 v17, v215, v47, v17
    v_dot2_f32_bf16 v18, v215, v51, v18
    v_dot2_f32_bf16 v19, v215, v55, v19
    v_dot2_f32_bf16 v20, v215, v59, v20
    s_waitcnt vmcnt(5)
    buffer_load_dwordx4 v[212:215], v2, s[44:47], s67 offen offset:2048 nt
    s_nop 0
    v_add_f32_dpp v17, v17, v17 row_ror:8 row_mask:0xf bank_mask:0x3
    v_add_f32_dpp v18, v18, v18 row_ror:8 row_mask:0xf bank_mask:0x3
    v_add_f32_dpp v17, v19, v19 row_ror:8 row_mask:0xf bank_mask:0xc
    v_add_f32_dpp v18, v20, v20 row_ror:8 row_mask:0xf bank_mask:0xc
    s_nop 1
    v_add_f32_dpp v23, v17, v17 row_half_mirror row_mask:0xf bank_mask:0x5
    v_add_f32_dpp v23, v18, v18 row_half_mirror row_mask:0xf bank_mask:0xa
    s_nop 1
    v_add_f32_dpp v23, v23, v23 quad_perm:[1,0,3,2] row_mask:0xf bank_mask:0xf
    s_nop 1
    v_add_f32_dpp v23, v23, v23 quad_perm:[2,3,0,1] row_mask:0xf bank_mask:0xf
    v_dot2_f32_bf16 v17, v216, v44, 0
    v_dot2_f32_bf16 v18, v216, v48, 0
    v_dot2_f32_bf16 v19, v216, v52, 0
    v_dot2_f32_bf16 v20, v216, v56, 0
    v_dot2_f32_bf16 v17, v217, v45, v17
    v_dot2_f32_bf16 v18, v217, v49, v18
    v_dot2_f32_bf16 v19, v217, v53, v19
    v_dot2_f32_bf16 v20, v217, v57, v20
    v_dot2_f32_bf16 v17, v218, v46, v17
    v_dot2_f32_bf16 v18, v218, v50, v18
    v_dot2_f32_bf16 v19, v218, v54, v19
    v_dot2_f32_bf16 v20, v218, v58, v20
    v_dot2_f32_bf16 v17, v219, v47, v17
    v_dot2_f32_bf16 v18, v219, v51, v18
    v_dot2_f32_bf16 v19, v219, v55, v19
    v_dot2_f32_bf16 v20, v219, v59, v20
    s_waitcnt vmcnt(5)
    buffer_load_dwordx4 v[216:219], v2, s[44:47], s67 offen offset:3072 nt
    s_nop 0
    v_add_f32_dpp v17, v17, v17 row_ror:8 row_mask:0xf bank_mask:0x3
    v_add_f32_dpp v18, v18, v18 row_ror:8 row_mask:0xf bank_mask:0x3
    v_add_f32_dpp v17, v19, v19 row_ror:8 row_mask:0xf bank_mask:0xc
    v_add_f32_dpp v18, v20, v20 row_ror:8 row_mask:0xf bank_mask:0xc
    s_nop 1
    v_add_f32_dpp v24, v17, v17 row_half_mirror row_mask:0xf bank_mask:0x5
    v_add_f32_dpp v24, v18, v18 row_half_mirror row_mask:0xf bank_mask:0xa
    s_nop 1
    v_add_f32_dpp v24, v24, v24 quad_perm:[1,0,3,2] row_mask:0xf bank_mask:0xf
    s_nop 1
    v_add_f32_dpp v24, v24, v24 quad_perm:[2,3,0,1] row_mask:0xf bank_mask:0xf
    v_max3_f32 v7, v21, v22, v23
    v_max_f32 v7, v7, v24
    v_cmp_gt_f32 vcc, v7, v14
    s_cbranch_vccnz SLOWB_49
BACKB_50:
    v_fma_f32 v25, v21, v5, -v15
    v_fma_f32 v26, v22, v5, -v15
    v_fma_f32 v27, v23, v5, -v15
    v_fma_f32 v28, v24, v5, -v15
    v_exp_f32 v25, v25
    v_exp_f32 v26, v26
    v_exp_f32 v27, v27
    v_exp_f32 v28, v28
    s_nop 0
    v_add_f32 v16, v16, v25
    v_cvt_pk_bf16_f32 v25, v25, v25
    v_add_f32 v16, v16, v26
    v_cvt_pk_bf16_f32 v26, v26, v26
    v_add_f32 v16, v16, v27
    v_cvt_pk_bf16_f32 v27, v27, v27
    v_add_f32 v16, v16, v28
    v_cvt_pk_bf16_f32 v28, v28, v28
    v_and_b32 v30, v25, v3
    v_and_b32 v31, v25, v4
    v_and_b32 v32, v26, v3
    v_and_b32 v33, v26, v4
    v_and_b32 v34, v27, v3
    v_and_b32 v35, v27, v4
    v_and_b32 v36, v28, v3
    v_and_b32 v37, v28, v4
    s_nop 0
    v_mfma_f32_16x16x16_bf16 v[68:71], v[30:31], v[220:221], v[68:71]
    v_mfma_f32_16x16x16_bf16 v[72:75], v[30:31], v[222:223], v[72:75]
    s_waitcnt vmcnt(5)
    buffer_load_dwordx4 v[220:223], v2, s[48:51], s67 offen nt
    v_mfma_f32_16x16x16_bf16 v[68:71], v[32:33], v[224:225], v[68:71]
    v_mfma_f32_16x16x16_bf16 v[72:75], v[32:33], v[226:227], v[72:75]
    s_waitcnt vmcnt(5)
    buffer_load_dwordx4 v[224:227], v2, s[48:51], s67 offen offset:1024 nt
    v_mfma_f32_16x16x16_bf16 v[68:71], v[34:35], v[228:229], v[68:71]
    v_mfma_f32_16x16x16_bf16 v[72:75], v[34:35], v[230:231], v[72:75]
    s_waitcnt vmcnt(5)
    buffer_load_dwordx4 v[228:231], v2, s[48:51], s67 offen offset:2048 nt
    v_mfma_f32_16x16x16_bf16 v[68:71], v[36:37], v[232:233], v[68:71]
    v_mfma_f32_16x16x16_bf16 v[72:75], v[36:37], v[234:235], v[72:75]
    s_waitcnt vmcnt(5)
    buffer_load_dwordx4 v[232:235], v2, s[48:51], s67 offen offset:3072 nt
    s_cmp_lg_u32 s9, 12
    s_cbranch_scc1 LOOP_B
    v_mov_b32 v8, v16
    s_nop 1
    v_permlane16_swap_b32 v16, v8
    s_nop 0
    v_add_f32 v16, v16, v8
    v_mov_b32 v8, v16
    s_nop 1
    v_permlane32_swap_b32 v16, v8
    s_nop 0
    v_add_f32 v16, v16, v8
    v_lshlrev_b32 v7, 5, v0
    s_lshl_b32 s10, s8, 11
    v_add_u32 v7, s10, v7
    ds_write_b128 v7, v[68:71] offset:5632
    ds_write_b128 v7, v[72:75] offset:5648
    s_lshl_b32 s10, s8, 3
    v_lshlrev_b32 v8, 3, v0
    v_add_u32 v8, s10, v8
    v_mov_b32 v30, v15
    v_mov_b32 v31, v16
    s_mov_b64 exec, 0x1111
    ds_write_b64 v8, v[30:31] offset:13824
    s_mov_b64 exec, 1
    v_mov_b32 v9, 0
    v_mov_b32 v32, 1
    s_waitcnt lgkmcnt(0)
    ds_add_u32 v9, v32 offset:4164
    s_mov_b64 exec, -1
    s_branch LOOP_A
SLOWB_43:
    v_mov_b32 v8, v7
    s_nop 1
    v_permlane16_swap_b32 v7, v8
    s_nop 0
    v_max_f32 v7, v7, v8
    v_mov_b32 v8, v7
    s_nop 1
    v_permlane32_swap_b32 v7, v8
    s_nop 0
    v_max_f32 v7, v7, v8
    v_max_f32 v14, v7, v14
    v_mul_f32 v9, v14, v5
    v_sub_f32 v8, v15, v9
    v_exp_f32 v8, v8
    v_mov_b32 v15, v9
    ds_bpermute_b32 v9, v6, v8
    v_mul_f32 v16, v16, v8
    s_waitcnt lgkmcnt(0)
    v_mul_f32 v68, v68, v9
    v_mul_f32 v69, v69, v9
    v_mul_f32 v70, v70, v9
    v_mul_f32 v71, v71, v9
    v_mul_f32 v72, v72, v9
    v_mul_f32 v73, v73, v9
    v_mul_f32 v74, v74, v9
    v_mul_f32 v75, v75, v9
    s_branch BACKB_44
SLOWB_45:
    v_mov_b32 v8, v7
    s_nop 1
    v_permlane16_swap_b32 v7, v8
    s_nop 0
    v_max_f32 v7, v7, v8
    v_mov_b32 v8, v7
    s_nop 1
    v_permlane32_swap_b32 v7, v8
    s_nop 0
    v_max_f32 v7, v7, v8
    v_max_f32 v14, v7, v14
    v_mul_f32 v9, v14, v5
    v_sub_f32 v8, v15, v9
    v_exp_f32 v8, v8
    v_mov_b32 v15, v9
    ds_bpermute_b32 v9, v6, v8
    v_mul_f32 v16, v16, v8
    s_waitcnt lgkmcnt(0)
    v_mul_f32 v68, v68, v9
    v_mul_f32 v69, v69, v9
    v_mul_f32 v70, v70, v9
    v_mul_f32 v71, v71, v9
    v_mul_f32 v72, v72, v9
    v_mul_f32 v73, v73, v9
    v_mul_f32 v74, v74, v9
    v_mul_f32 v75, v75, v9
    s_branch BACKB_46
SLOWB_47:
    v_mov_b32 v8, v7
    s_nop 1
    v_permlane16_swap_b32 v7, v8
    s_nop 0
    v_max_f32 v7, v7, v8
    v_mov_b32 v8, v7
    s_nop 1
    v_permlane32_swap_b32 v7, v8
    s_nop 0
    v_max_f32 v7, v7, v8
    v_max_f32 v14, v7, v14
    v_mul_f32 v9, v14, v5
    v_sub_f32 v8, v15, v9
    v_exp_f32 v8, v8
    v_mov_b32 v15, v9
    ds_bpermute_b32 v9, v6, v8
    v_mul_f32 v16, v16, v8
    s_waitcnt lgkmcnt(0)
    v_mul_f32 v68, v68, v9
    v_mul_f32 v69, v69, v9
    v_mul_f32 v70, v70, v9
    v_mul_f32 v71, v71, v9
    v_mul_f32 v72, v72, v9
    v_mul_f32 v73, v73, v9
    v_mul_f32 v74, v74, v9
    v_mul_f32 v75, v75, v9
    s_branch BACKB_48
SLOWB_49:
    v_mov_b32 v8, v7
    s_nop 1
    v_permlane16_swap_b32 v7, v8
    s_nop 0
    v_max_f32 v7, v7, v8
    v_mov_b32 v8, v7
    s_nop 1
    v_permlane32_swap_b32 v7, v8
    s_nop 0
    v_max_f32 v7, v7, v8
    v_max_f32 v14, v7, v14
    v_mul_f32 v9, v14, v5
    v_sub_f32 v8, v15, v9
    v_exp_f32 v8, v8
    v_mov_b32 v15, v9
    ds_bpermute_b32 v9, v6, v8
    v_mul_f32 v16, v16, v8
    s_waitcnt lgkmcnt(0)
    v_mul_f32 v68, v68, v9
    v_mul_f32 v69, v69, v9
    v_mul_f32 v70, v70, v9
    v_mul_f32 v71, v71, v9
    v_mul_f32 v72, v72, v9
    v_mul_f32 v73, v73, v9
    v_mul_f32 v74, v74, v9
    v_mul_f32 v75, v75, v9
    s_branch BACKB_50
.p2align 6
HELPER:
    s_sub_u32 s13, s8, 4
    v_lshrrev_b32 v4, 4, v0
    v_and_b32 v5, 15, v0
    v_lshl_add_u32 v8, v5, 2, v4
    v_lshlrev_b32 v8, 1, v8
    v_lshlrev_b32 v9, 13, v4
    v_lshl_add_u32 v9, v5, 4, v9
    s_mov_b32 s44, s16
    s_mov_b32 s45, s17
    s_mov_b32 s46, 8192
    s_mov_b32 s47, 0x20000
    s_mov_b32 s48, s22
    s_mov_b32 s49, s23
    s_mov_b32 s50, 0x400000
    s_mov_b32 s51, 0x20000
    s_lshl_b32 s42, s4, 10
    s_lshl_b32 s11, s13, 8
    s_add_u32 s42, s42, s11
    s_lshl_b32 s43, s13, 20
    s_lshl_b32 s11, s6, 8
    s_add_u32 s43, s43, s11
    s_mov_b32 s15, 0x8000
    s_mov_b32 s9, 0
QLOOP:
    buffer_load_ushort v10, v8, s[44:47], s42 offen
    buffer_load_ushort v11, v8, s[44:47], s42 offen offset:128
    s_cmp_lg_u32 s9, 0
    s_cbranch_scc1 QPACED
    buffer_load_dwordx4 v[116:119], v9, s[48:51], s43 offen nt
    s_add_u32 s43, s43, s15
    buffer_load_dwordx4 v[120:123], v9, s[48:51], s43 offen nt
    s_add_u32 s43, s43, s15
    buffer_load_dwordx4 v[124:127], v9, s[48:51], s43 offen nt
    s_add_u32 s43, s43, s15
    buffer_load_dwordx4 v[128:131], v9, s[48:51], s43 offen nt
    s_add_u32 s43, s43, s15
    buffer_load_dwordx4 v[132:135], v9, s[48:51], s43 offen nt
    s_add_u32 s43, s43, s15
    buffer_load_dwordx4 v[136:139], v9, s[48:51], s43 offen nt
    s_add_u32 s43, s43, s15
    buffer_load_dwordx4 v[140:143], v9, s[48:51], s43 offen nt
    s_add_u32 s43, s43, s15
    buffer_load_dwordx4 v[144:147], v9, s[48:51], s43 offen nt
    s_add_u32 s43, s43, s15
    buffer_load_dwordx4 v[148:151], v9, s[48:51], s43 offen nt
    s_add_u32 s43, s43, s15
    buffer_load_dwordx4 v[152:155], v9, s[48:51], s43 offen nt
    s_add_u32 s43, s43, s15
    buffer_load_dwordx4 v[156:159], v9, s[48:51], s43 offen nt
    s_add_u32 s43, s43, s15
    buffer_load_dwordx4 v[160:163], v9, s[48:51], s43 offen nt
    s_add_u32 s43, s43, s15
    buffer_load_dwordx4 v[164:167], v9, s[48:51], s43 offen nt
    s_add_u32 s43, s43, s15
    buffer_load_dwordx4 v[168:171], v9, s[48:51], s43 offen nt
    s_add_u32 s43, s43, s15
    buffer_load_dwordx4 v[172:175], v9, s[48:51], s43 offen nt
    s_add_u32 s43, s43, s15
    buffer_load_dwordx4 v[176:179], v9, s[48:51], s43 offen nt
    s_add_u32 s43, s43, s15
    buffer_load_dwordx4 v[180:183], v9, s[48:51], s43 offen nt
    s_add_u32 s43, s43, s15
    buffer_load_dwordx4 v[184:187], v9, s[48:51], s43 offen nt
    s_add_u32 s43, s43, s15
    buffer_load_dwordx4 v[188:191], v9, s[48:51], s43 offen nt
    s_add_u32 s43, s43, s15
    buffer_load_dwordx4 v[192:195], v9, s[48:51], s43 offen nt
    s_add_u32 s43, s43, s15
    buffer_load_dwordx4 v[196:199], v9, s[48:51], s43 offen nt
    s_add_u32 s43, s43, s15
    buffer_load_dwordx4 v[200:203], v9, s[48:51], s43 offen nt
    s_add_u32 s43, s43, s15
    buffer_load_dwordx4 v[204:207], v9, s[48:51], s43 offen nt
    s_add_u32 s43, s43, s15
    buffer_load_dwordx4 v[208:211], v9, s[48:51], s43 offen nt
    s_add_u32 s43, s43, s15
    buffer_load_dwordx4 v[212:215], v9, s[48:51], s43 offen nt
    s_add_u32 s43, s43, s15
    buffer_load_dwordx4 v[216:219], v9, s[48:51], s43 offen nt
    s_add_u32 s43, s43, s15
    buffer_load_dwordx4 v[220:223], v9, s[48:51], s43 offen nt
    s_add_u32 s43, s43, s15
    buffer_load_dwordx4 v[224:227], v9, s[48:51], s43 offen nt
    s_add_u32 s43, s43, s15
    buffer_load_dwordx4 v[228:231], v9, s[48:51], s43 offen nt
    s_add_u32 s43, s43, s15
    buffer_load_dwordx4 v[232:235], v9, s[48:51], s43 offen nt
    s_add_u32 s43, s43, s15
    buffer_load_dwordx4 v[236:239], v9, s[48:51], s43 offen nt
    s_add_u32 s43, s43, s15
    buffer_load_dwordx4 v[240:243], v9, s[48:51], s43 offen nt
    s_add_u32 s43, s43, s15
QLOADED:
    s_add_u32 s42, s42, 256
    s_cmp_gt_u32 s9, 1
    s_cbranch_scc1 QNOINIT
    s_cmp_eq_u32 s9, 1
    s_cbranch_scc1 QNOBAR
    s_barrier
QNOBAR:
    v_and_b32 v2, 3, v0
    v_mov_b32 v6, 0
    v_mov_b32 v7, 0
    v_cmp_eq_u32 vcc, 0, v2
    v_mov_b32 v3, 1
    s_nop 0
    v_cndmask_b32 v6, v6, v3, vcc
    v_cmp_eq_u32 vcc, 1, v2
    v_mov_b32 v3, 0x10000
    s_nop 0
    v_cndmask_b32 v6, v6, v3, vcc
    v_cmp_eq_u32 vcc, 2, v2
    v_mov_b32 v3, 1
    s_nop 0
    v_cndmask_b32 v7, v7, v3, vcc
    v_cmp_eq_u32 vcc, 3, v2
    v_mov_b32 v3, 0x10000
    s_nop 0
    v_cndmask_b32 v7, v7, v3, vcc
    v_mov_b32 v36, 0
    v_mov_b32 v37, 0
    v_mov_b32 v38, 0
    v_mov_b32 v39, 0
    v_mov_b32 v40, 0
    v_mov_b32 v41, 0
    v_mov_b32 v42, 0
    v_mov_b32 v43, 0
QNOINIT:
    s_waitcnt vmcnt(32)
    v_mul_u32_u24_dpp v52, v10, v6 row_newbcast:0 row_mask:0xf bank_mask:0xf
    v_mul_u32_u24_dpp v53, v10, v7 row_newbcast:0 row_mask:0xf bank_mask:0xf
    v_mul_u32_u24_dpp v54, v10, v6 row_newbcast:1 row_mask:0xf bank_mask:0xf
    v_mul_u32_u24_dpp v55, v10, v7 row_newbcast:1 row_mask:0xf bank_mask:0xf
    v_mul_u32_u24_dpp v56, v10, v6 row_newbcast:2 row_mask:0xf bank_mask:0xf
    v_mul_u32_u24_dpp v57, v10, v7 row_newbcast:2 row_mask:0xf bank_mask:0xf
    v_mul_u32_u24_dpp v58, v10, v6 row_newbcast:3 row_mask:0xf bank_mask:0xf
    v_mul_u32_u24_dpp v59, v10, v7 row_newbcast:3 row_mask:0xf bank_mask:0xf
    v_mul_u32_u24_dpp v60, v10, v6 row_newbcast:4 row_mask:0xf bank_mask:0xf
    v_mul_u32_u24_dpp v61, v10, v7 row_newbcast:4 row_mask:0xf bank_mask:0xf
    v_mul_u32_u24_dpp v62, v10, v6 row_newbcast:5 row_mask:0xf bank_mask:0xf
    v_mul_u32_u24_dpp v63, v10, v7 row_newbcast:5 row_mask:0xf bank_mask:0xf
    v_mul_u32_u24_dpp v64, v10, v6 row_newbcast:6 row_mask:0xf bank_mask:0xf
    v_mul_u32_u24_dpp v65, v10, v7 row_newbcast:6 row_mask:0xf bank_mask:0xf
    v_mul_u32_u24_dpp v66, v10, v6 row_newbcast:7 row_mask:0xf bank_mask:0xf
    v_mul_u32_u24_dpp v67, v10, v7 row_newbcast:7 row_mask:0xf bank_mask:0xf
    v_mul_u32_u24_dpp v68, v10, v6 row_newbcast:8 row_mask:0xf bank_mask:0xf
    v_mul_u32_u24_dpp v69, v10, v7 row_newbcast:8 row_mask:0xf bank_mask:0xf
    v_mul_u32_u24_dpp v70, v10, v6 row_newbcast:9 row_mask:0xf bank_mask:0xf
    v_mul_u32_u24_dpp v71, v10, v7 row_newbcast:9 row_mask:0xf bank_mask:0xf
    v_mul_u32_u24_dpp v72, v10, v6 row_newbcast:10 row_mask:0xf bank_mask:0xf
    v_mul_u32_u24_dpp v73, v10, v7 row_newbcast:10 row_mask:0xf bank_mask:0xf
    v_mul_u32_u24_dpp v74, v10, v6 row_newbcast:11 row_mask:0xf bank_mask:0xf
    v_mul_u32_u24_dpp v75, v10, v7 row_newbcast:11 row_mask:0xf bank_mask:0xf
    v_mul_u32_u24_dpp v76, v10, v6 row_newbcast:12 row_mask:0xf bank_mask:0xf
    v_mul_u32_u24_dpp v77, v10, v7 row_newbcast:12 row_mask:0xf bank_mask:0xf
    v_mul_u32_u24_dpp v78, v10, v6 row_newbcast:13 row_mask:0xf bank_mask:0xf
    v_mul_u32_u24_dpp v79, v10, v7 row_newbcast:13 row_mask:0xf bank_mask:0xf
    v_mul_u32_u24_dpp v80, v10, v6 row_newbcast:14 row_mask:0xf bank_mask:0xf
    v_mul_u32_u24_dpp v81, v10, v7 row_newbcast:14 row_mask:0xf bank_mask:0xf
    v_mul_u32_u24_dpp v82, v10, v6 row_newbcast:15 row_mask:0xf bank_mask:0xf
    v_mul_u32_u24_dpp v83, v10, v7 row_newbcast:15 row_mask:0xf bank_mask:0xf
    v_mul_u32_u24_dpp v84, v11, v6 row_newbcast:0 row_mask:0xf bank_mask:0xf
    v_mul_u32_u24_dpp v85, v11, v7 row_newbcast:0 row_mask:0xf bank_mask:0xf
    v_mul_u32_u24_dpp v86, v11, v6 row_newbcast:1 row_mask:0xf bank_mask:0xf
    v_mul_u32_u24_dpp v87, v11, v7 row_newbcast:1 row_mask:0xf bank_mask:0xf
    v_mul_u32_u24_dpp v88, v11, v6 row_newbcast:2 row_mask:0xf bank_mask:0xf
    v_mul_u32_u24_dpp v89, v11, v7 row_newbcast:2 row_mask:0xf bank_mask:0xf
    v_mul_u32_u24_dpp v90, v11, v6 row_newbcast:3 row_mask:0xf bank_mask:0xf
    v_mul_u32_u24_dpp v91, v11, v7 row_newbcast:3 row_mask:0xf bank_mask:0xf
    v_mul_u32_u24_dpp v92, v11, v6 row_newbcast:4 row_mask:0xf bank_mask:0xf
    v_mul_u32_u24_dpp v93, v11, v7 row_newbcast:4 row_mask:0xf bank_mask:0xf
    v_mul_u32_u24_dpp v94, v11, v6 row_newbcast:5 row_mask:0xf bank_mask:0xf
    v_mul_u32_u24_dpp v95, v11, v7 row_newbcast:5 row_mask:0xf bank_mask:0xf
    v_mul_u32_u24_dpp v96, v11, v6 row_newbcast:6 row_mask:0xf bank_mask:0xf
    v_mul_u32_u24_dpp v97, v11, v7 row_newbcast:6 row_mask:0xf bank_mask:0xf
    v_mul_u32_u24_dpp v98, v11, v6 row_newbcast:7 row_mask:0xf bank_mask:0xf
    v_mul_u32_u24_dpp v99, v11, v7 row_newbcast:7 row_mask:0xf bank_mask:0xf
    v_mul_u32_u24_dpp v100, v11, v6 row_newbcast:8 row_mask:0xf bank_mask:0xf
    v_mul_u32_u24_dpp v101, v11, v7 row_newbcast:8 row_mask:0xf bank_mask:0xf
    v_mul_u32_u24_dpp v102, v11, v6 row_newbcast:9 row_mask:0xf bank_mask:0xf
    v_mul_u32_u24_dpp v103, v11, v7 row_newbcast:9 row_mask:0xf bank_mask:0xf
    v_mul_u32_u24_dpp v104, v11, v6 row_newbcast:10 row_mask:0xf bank_mask:0xf
    v_mul_u32_u24_dpp v105, v11, v7 row_newbcast:10 row_mask:0xf bank_mask:0xf
    v_mul_u32_u24_dpp v106, v11, v6 row_newbcast:11 row_mask:0xf bank_mask:0xf
    v_mul_u32_u24_dpp v107, v11, v7 row_newbcast:11 row_mask:0xf bank_mask:0xf
    v_mul_u32_u24_dpp v108, v11, v6 row_newbcast:12 row_mask:0xf bank_mask:0xf
    v_mul_u32_u24_dpp v109, v11, v7 row_newbcast:12 row_mask:0xf bank_mask:0xf
    v_mul_u32_u24_dpp v110, v11, v6 row_newbcast:13 row_mask:0xf bank_mask:0xf
    v_mul_u32_u24_dpp v111, v11, v7 row_newbcast:13 row_mask:0xf bank_mask:0xf
    v_mul_u32_u24_dpp v112, v11, v6 row_newbcast:14 row_mask:0xf bank_mask:0xf
    v_mul_u32_u24_dpp v113, v11, v7 row_newbcast:14 row_mask:0xf bank_mask:0xf
    v_mul_u32_u24_dpp v114, v11, v6 row_newbcast:15 row_mask:0xf bank_mask:0xf
    v_mul_u32_u24_dpp v115, v11, v7 row_newbcast:15 row_mask:0xf bank_mask:0xf
    s_waitcnt vmcnt(31)
    v_mfma_f32_16x16x16_bf16 v[36:39], v[52:53], v[116:117], v[36:39]
    v_mfma_f32_16x16x16_bf16 v[40:43], v[52:53], v[118:119], v[40:43]
    s_waitcnt vmcnt(30)
    v_mfma_f32_16x16x16_bf16 v[36:39], v[54:55], v[120:121], v[36:39]
    v_mfma_f32_16x16x16_bf16 v[40:43], v[54:55], v[122:123], v[40:43]
    s_waitcnt vmcnt(29)
    v_mfma_f32_16x16x16_bf16 v[36:39], v[56:57], v[124:125], v[36:39]
    v_mfma_f32_16x16x16_bf16 v[40:43], v[56:57], v[126:127], v[40:43]
    s_waitcnt vmcnt(28)
    v_mfma_f32_16x16x16_bf16 v[36:39], v[58:59], v[128:129], v[36:39]
    v_mfma_f32_16x16x16_bf16 v[40:43], v[58:59], v[130:131], v[40:43]
    s_waitcnt vmcnt(27)
    v_mfma_f32_16x16x16_bf16 v[36:39], v[60:61], v[132:133], v[36:39]
    v_mfma_f32_16x16x16_bf16 v[40:43], v[60:61], v[134:135], v[40:43]
    s_waitcnt vmcnt(26)
    v_mfma_f32_16x16x16_bf16 v[36:39], v[62:63], v[136:137], v[36:39]
    v_mfma_f32_16x16x16_bf16 v[40:43], v[62:63], v[138:139], v[40:43]
    s_waitcnt vmcnt(25)
    v_mfma_f32_16x16x16_bf16 v[36:39], v[64:65], v[140:141], v[36:39]
    v_mfma_f32_16x16x16_bf16 v[40:43], v[64:65], v[142:143], v[40:43]
    s_waitcnt vmcnt(24)
    v_mfma_f32_16x16x16_bf16 v[36:39], v[66:67], v[144:145], v[36:39]
    v_mfma_f32_16x16x16_bf16 v[40:43], v[66:67], v[146:147], v[40:43]
    s_waitcnt vmcnt(23)
    v_mfma_f32_16x16x16_bf16 v[36:39], v[68:69], v[148:149], v[36:39]
    v_mfma_f32_16x16x16_bf16 v[40:43], v[68:69], v[150:151], v[40:43]
    s_waitcnt vmcnt(22)
    v_mfma_f32_16x16x16_bf16 v[36:39], v[70:71], v[152:153], v[36:39]
    v_mfma_f32_16x16x16_bf16 v[40:43], v[70:71], v[154:155], v[40:43]
    s_waitcnt vmcnt(21)
    v_mfma_f32_16x16x16_bf16 v[36:39], v[72:73], v[156:157], v[36:39]
    v_mfma_f32_16x16x16_bf16 v[40:43], v[72:73], v[158:159], v[40:43]
    s_waitcnt vmcnt(20)
    v_mfma_f32_16x16x16_bf16 v[36:39], v[74:75], v[160:161], v[36:39]
    v_mfma_f32_16x16x16_bf16 v[40:43], v[74:75], v[162:163], v[40:43]
    s_waitcnt vmcnt(19)
    v_mfma_f32_16x16x16_bf16 v[36:39], v[76:77], v[164:165], v[36:39]
    v_mfma_f32_16x16x16_bf16 v[40:43], v[76:77], v[166:167], v[40:43]
    s_waitcnt vmcnt(18)
    v_mfma_f32_16x16x16_bf16 v[36:39], v[78:79], v[168:169], v[36:39]
    v_mfma_f32_16x16x16_bf16 v[40:43], v[78:79], v[170:171], v[40:43]
    s_waitcnt vmcnt(17)
    v_mfma_f32_16x16x16_bf16 v[36:39], v[80:81], v[172:173], v[36:39]
    v_mfma_f32_16x16x16_bf16 v[40:43], v[80:81], v[174:175], v[40:43]
    s_waitcnt vmcnt(16)
    v_mfma_f32_16x16x16_bf16 v[36:39], v[82:83], v[176:177], v[36:39]
    v_mfma_f32_16x16x16_bf16 v[40:43], v[82:83], v[178:179], v[40:43]
    s_waitcnt vmcnt(15)
    v_mfma_f32_16x16x16_bf16 v[36:39], v[84:85], v[180:181], v[36:39]
    v_mfma_f32_16x16x16_bf16 v[40:43], v[84:85], v[182:183], v[40:43]
    s_waitcnt vmcnt(14)
    v_mfma_f32_16x16x16_bf16 v[36:39], v[86:87], v[184:185], v[36:39]
    v_mfma_f32_16x16x16_bf16 v[40:43], v[86:87], v[186:187], v[40:43]
    s_waitcnt vmcnt(13)
    v_mfma_f32_16x16x16_bf16 v[36:39], v[88:89], v[188:189], v[36:39]
    v_mfma_f32_16x16x16_bf16 v[40:43], v[88:89], v[190:191], v[40:43]
    s_waitcnt vmcnt(12)
    v_mfma_f32_16x16x16_bf16 v[36:39], v[90:91], v[192:193], v[36:39]
    v_mfma_f32_16x16x16_bf16 v[40:43], v[90:91], v[194:195], v[40:43]
    s_waitcnt vmcnt(11)
    v_mfma_f32_16x16x16_bf16 v[36:39], v[92:93], v[196:197], v[36:39]
    v_mfma_f32_16x16x16_bf16 v[40:43], v[92:93], v[198:199], v[40:43]
    s_waitcnt vmcnt(10)
    v_mfma_f32_16x16x16_bf16 v[36:39], v[94:95], v[200:201], v[36:39]
    v_mfma_f32_16x16x16_bf16 v[40:43], v[94:95], v[202:203], v[40:43]
    s_waitcnt vmcnt(9)
    v_mfma_f32_16x16x16_bf16 v[36:39], v[96:97], v[204:205], v[36:39]
    v_mfma_f32_16x16x16_bf16 v[40:43], v[96:97], v[206:207], v[40:43]
    s_waitcnt vmcnt(8)
    v_mfma_f32_16x16x16_bf16 v[36:39], v[98:99], v[208:209], v[36:39]
    v_mfma_f32_16x16x16_bf16 v[40:43], v[98:99], v[210:211], v[40:43]
    s_waitcnt vmcnt(7)
    v_mfma_f32_16x16x16_bf16 v[36:39], v[100:101], v[212:213], v[36:39]
    v_mfma_f32_16x16x16_bf16 v[40:43], v[100:101], v[214:215], v[40:43]
    s_waitcnt vmcnt(6)
    v_mfma_f32_16x16x16_bf16 v[36:39], v[102:103], v[216:217], v[36:39]
    v_mfma_f32_16x16x16_bf16 v[40:43], v[102:103], v[218:219], v[40:43]
    s_waitcnt vmcnt(5)
    v_mfma_f32_16x16x16_bf16 v[36:39], v[104:105], v[220:221], v[36:39]
    v_mfma_f32_16x16x16_bf16 v[40:43], v[104:105], v[222:223], v[40:43]
    s_waitcnt vmcnt(4)
    v_mfma_f32_16x16x16_bf16 v[36:39], v[106:107], v[224:225], v[36:39]
    v_mfma_f32_16x16x16_bf16 v[40:43], v[106:107], v[226:227], v[40:43]
    s_waitcnt vmcnt(3)
    v_mfma_f32_16x16x16_bf16 v[36:39], v[108:109], v[228:229], v[36:39]
    v_mfma_f32_16x16x16_bf16 v[40:43], v[108:109], v[230:231], v[40:43]
    s_waitcnt vmcnt(2)
    v_mfma_f32_16x16x16_bf16 v[36:39], v[110:111], v[232:233], v[36:39]
    v_mfma_f32_16x16x16_bf16 v[40:43], v[110:111], v[234:235], v[40:43]
    s_waitcnt vmcnt(1)
    v_mfma_f32_16x16x16_bf16 v[36:39], v[112:113], v[236:237], v[36:39]
    v_mfma_f32_16x16x16_bf16 v[40:43], v[112:113], v[238:239], v[40:43]
    s_waitcnt vmcnt(0)
    v_mfma_f32_16x16x16_bf16 v[36:39], v[114:115], v[240:241], v[36:39]
    v_mfma_f32_16x16x16_bf16 v[40:43], v[114:115], v[242:243], v[40:43]
    s_add_u32 s9, s9, 1
    s_cmp_eq_u32 s9, 5
    s_cbranch_scc1 QB_DONE
    s_cmp_gt_u32 s9, 1
    s_cbranch_scc1 QLOOP
    v_lshlrev_b32 v2, 5, v5
    s_lshl_b32 s10, s13, 9
    v_add_u32 v2, s10, v2
    s_nop 3
    s_mov_b64 exec, 0xffff
    ds_write_b128 v2, v[36:39] offset:0
    ds_write_b128 v2, v[40:43] offset:16
    s_mov_b64 exec, -1
    s_waitcnt lgkmcnt(0)
    s_barrier
    s_mov_b32 s52, s40
    s_mov_b32 s53, s41
    s_mov_b32 s54, 0x400000
    s_mov_b32 s55, 0x20000
    v_mov_b32 v12, 0
    v_lshlrev_b32 v13, 5, v5
    v_lshrrev_b32 v2, 1, v5
    v_lshlrev_b32 v17, 7, v2
    v_and_b32 v2, 1, v4
    v_lshl_add_u32 v17, v2, 6, v17
    v_and_b32 v2, 1, v5
    v_lshl_add_u32 v17, v2, 5, v17
    v_lshrrev_b32 v2, 1, v4
    v_lshl_add_u32 v17, v2, 4, v17
    v_lshl_add_u32 v13, v4, 2, v13
    v_lshlrev_b32 v14, 10, v4
    v_lshl_add_u32 v14, v5, 4, v14
    v_lshlrev_b32 v19, 4, v0
    v_lshlrev_b32 v18, 5, v0
    v_mov_b32 v15, 0x05040100
    v_mov_b32 v16, 0x07060302
    s_mov_b32 s56, s38
    s_mov_b32 s57, s39
    s_mov_b32 s58, 256
    s_mov_b32 s59, 0x20000
    s_mov_b32 s60, s36
    s_mov_b32 s61, s37
    s_mov_b32 s62, 16384
    s_mov_b32 s63, 0x20000
    s_lshl_b32 s64, s4, 3
    s_add_u32 s64, s64, s3
    s_mul_i32 s65, s64, 8704
    s_add_u32 s65, s65, 131072
    s_lshl_b32 s66, s64, 10
    s_add_u32 s66, s66, 65536
    s_lshl_b32 s67, s7, 8
    s_add_u32 s67, s67, 65536
    s_lshl_b32 s68, s4, 12
    s_lshl_b32 s10, s3, 8
    s_add_u32 s68, s68, s10
    s_add_u32 s68, s68, 2032640
    s_lshl_b32 s69, s4, 2
    s_lshl_b32 s73, s4, 12
    s_add_u32 s73, s73, 2031616
    s_lshl_b32 s10, s13, 10
    s_lshl_b32 s70, s7, 12
    s_add_u32 s70, s70, s10
    s_add_u32 s70, s70, 2097152
    s_lshl_b32 s71, s4, 17
    s_lshl_b32 s10, s6, 7
    s_add_u32 s71, s71, s10
    s_add_u32 s71, s71, 2097152
    s_cmp_eq_u32 s13, 0
    s_cbranch_scc1 H0_QB
    s_cmp_eq_u32 s13, 1
    s_cbranch_scc1 H_SET_B
    s_cmp_eq_u32 s13, 3
    s_cbranch_scc1 H_DMA
    s_mov_b32 s44, s28
    s_mov_b32 s45, s29
    s_mov_b32 s46, 0x4000000
    s_mov_b32 s47, 0x20000
    buffer_load_dword v21, v12, s[44:47], s14 offen nt
    s_mov_b32 s44, s30
    s_mov_b32 s45, s31
    s_mov_b32 s46, 0x4000000
    s_mov_b32 s47, 0x20000
    buffer_load_dword v21, v12, s[44:47], s14 offen nt
    s_cmp_lg_u32 s6, 0
    s_cbranch_scc1 H_DMA
    v_mov_b32 v52, 0
    v_mov_b32 v53, 0
    v_mov_b32 v54, 0
    v_mov_b32 v55, 0
    s_lshl_b32 s10, s4, 12
    s_add_u32 s10, s10, 2031616
    buffer_store_dwordx4 v[52:55], v19, s[52:55], s10 offen offset:0 sc1
    buffer_store_dwordx4 v[52:55], v19, s[52:55], s10 offen offset:1024 sc1
    buffer_store_dwordx4 v[52:55], v19, s[52:55], s10 offen offset:2048 sc1
    v_mov_b32 v2, 1
    s_waitcnt vmcnt(0)
    s_mov_b64 exec, 1
    buffer_store_dword v2, v12, s[56:59], s69 offen sc1
    s_mov_b64 exec, -1
H_DMA:
    s_mov_b32 s48, s24
    s_mov_b32 s49, s25
    s_mov_b32 s50, 0x400000
    s_mov_b32 s51, 0x20000
    s_sub_u32 s10, s13, 2
    s_lshl_b32 s42, s10, 16
    s_add_u32 s42, s42, 16384
    s_lshl_b32 s10, s10, 9
    s_lshl_b32 s11, s6, 17
    s_add_u32 s11, s11, s10
    s_mov_b32 s9, 0
H_DMAL:
    s_and_b32 s10, s9, 31
    s_lshl_b32 s10, s10, 12
    s_lshr_b32 s43, s9, 5
    s_lshl_b32 s43, s43, 8
    s_add_u32 s43, s43, s10
    s_add_u32 s43, s43, s11
    s_mov_b32 m0, s42
    s_waitcnt vmcnt(1)
    buffer_load_dwordx4 v14, s[48:51], s43 offen nt lds
    s_add_u32 s42, s42, 1024
    s_add_u32 s9, s9, 1
    s_cmp_lt_u32 s9, 64
    s_cbranch_scc1 H_DMAL
    v_mov_b32 v2, 1
    s_waitcnt vmcnt(0)
    s_mov_b64 exec, 1
    ds_add_u32 v12, v2 offset:4180
    s_mov_b64 exec, -1
    s_branch H_SET_B
H0_QB:
    s_mov_b32 s44, s26
    s_mov_b32 s45, s27
    s_mov_b32 s46, 8192
    s_mov_b32 s47, 0x20000
    s_mov_b32 s48, s32
    s_mov_b32 s49, s33
    s_mov_b32 s50, 0x400000
    s_mov_b32 s51, 0x20000
    s_lshl_b32 s42, s4, 10
    s_lshl_b32 s43, s6, 8
    s_branch QLOOP
QPACED:
    buffer_load_dwordx4 v[116:119], v9, s[48:51], s43 offen nt
    s_add_u32 s43, s43, s15
    buffer_load_dwordx4 v[120:123], v9, s[48:51], s43 offen nt
    s_add_u32 s43, s43, s15
    buffer_load_dwordx4 v[124:127], v9, s[48:51], s43 offen nt
    s_add_u32 s43, s43, s15
    buffer_load_dwordx4 v[128:131], v9, s[48:51], s43 offen nt
    s_add_u32 s43, s43, s15
    buffer_load_dwordx4 v[132:135], v9, s[48:51], s43 offen nt
    s_add_u32 s43, s43, s15
    buffer_load_dwordx4 v[136:139], v9, s[48:51], s43 offen nt
    s_add_u32 s43, s43, s15
    s_waitcnt vmcnt(5)
    buffer_load_dwordx4 v[140:143], v9, s[48:51], s43 offen nt
    s_add_u32 s43, s43, s15
    s_waitcnt vmcnt(5)
    buffer_load_dwordx4 v[144:147], v9, s[48:51], s43 offen nt
    s_add_u32 s43, s43, s15
    s_waitcnt vmcnt(5)
    buffer_load_dwordx4 v[148:151], v9, s[48:51], s43 offen nt
    s_add_u32 s43, s43, s15
    s_waitcnt vmcnt(5)
    buffer_load_dwordx4 v[152:155], v9, s[48:51], s43 offen nt
    s_add_u32 s43, s43, s15
    s_waitcnt vmcnt(5)
    buffer_load_dwordx4 v[156:159], v9, s[48:51], s43 offen nt
    s_add_u32 s43, s43, s15
    s_waitcnt vmcnt(5)
    buffer_load_dwordx4 v[160:163], v9, s[48:51], s43 offen nt
    s_add_u32 s43, s43, s15
    s_waitcnt vmcnt(5)
    buffer_load_dwordx4 v[164:167], v9, s[48:51], s43 offen nt
    s_add_u32 s43, s43, s15
    s_waitcnt vmcnt(5)
    buffer_load_dwordx4 v[168:171], v9, s[48:51], s43 offen nt
    s_add_u32 s43, s43, s15
    s_waitcnt vmcnt(5)
    buffer_load_dwordx4 v[172:175], v9, s[48:51], s43 offen nt
    s_add_u32 s43, s43, s15
    s_waitcnt vmcnt(5)
    buffer_load_dwordx4 v[176:179], v9, s[48:51], s43 offen nt
    s_add_u32 s43, s43, s15
    s_waitcnt vmcnt(5)
    buffer_load_dwordx4 v[180:183], v9, s[48:51], s43 offen nt
    s_add_u32 s43, s43, s15
    s_waitcnt vmcnt(5)
    buffer_load_dwordx4 v[184:187], v9, s[48:51], s43 offen nt
    s_add_u32 s43, s43, s15
    s_waitcnt vmcnt(5)
    buffer_load_dwordx4 v[188:191], v9, s[48:51], s43 offen nt
    s_add_u32 s43, s43, s15
    s_waitcnt vmcnt(5)
    buffer_load_dwordx4 v[192:195], v9, s[48:51], s43 offen nt
    s_add_u32 s43, s43, s15
    s_waitcnt vmcnt(5)
    buffer_load_dwordx4 v[196:199], v9, s[48:51], s43 offen nt
    s_add_u32 s43, s43, s15
    s_waitcnt vmcnt(5)
    buffer_load_dwordx4 v[200:203], v9, s[48:51], s43 offen nt
    s_add_u32 s43, s43, s15
    s_waitcnt vmcnt(5)
    buffer_load_dwordx4 v[204:207], v9, s[48:51], s43 offen nt
    s_add_u32 s43, s43, s15
    s_waitcnt vmcnt(5)
    buffer_load_dwordx4 v[208:211], v9, s[48:51], s43 offen nt
    s_add_u32 s43, s43, s15
    s_waitcnt vmcnt(5)
    buffer_load_dwordx4 v[212:215], v9, s[48:51], s43 offen nt
    s_add_u32 s43, s43, s15
    s_waitcnt vmcnt(5)
    buffer_load_dwordx4 v[216:219], v9, s[48:51], s43 offen nt
    s_add_u32 s43, s43, s15
    s_waitcnt vmcnt(5)
    buffer_load_dwordx4 v[220:223], v9, s[48:51], s43 offen nt
    s_add_u32 s43, s43, s15
    s_waitcnt vmcnt(5)
    buffer_load_dwordx4 v[224:227], v9, s[48:51], s43 offen nt
    s_add_u32 s43, s43, s15
    s_waitcnt vmcnt(5)
    buffer_load_dwordx4 v[228:231], v9, s[48:51], s43 offen nt
    s_add_u32 s43, s43, s15
    s_waitcnt vmcnt(5)
    buffer_load_dwordx4 v[232:235], v9, s[48:51], s43 offen nt
    s_add_u32 s43, s43, s15
    s_waitcnt vmcnt(5)
    buffer_load_dwordx4 v[236:239], v9, s[48:51], s43 offen nt
    s_add_u32 s43, s43, s15
    s_waitcnt vmcnt(5)
    buffer_load_dwordx4 v[240:243], v9, s[48:51], s43 offen nt
    s_add_u32 s43, s43, s15
    s_branch QLOADED
QB_DONE:
    s_nop 5
    v_cvt_pk_bf16_f32 v52, v36, v37
    v_cvt_pk_bf16_f32 v53, v38, v39
    v_cvt_pk_bf16_f32 v54, v40, v41
    v_cvt_pk_bf16_f32 v55, v42, v43
    s_mov_b64 exec, 0xffff
    buffer_store_dwordx4 v[52:55], v19, s[52:55], s67 offen sc1
    s_mov_b64 exec, -1
    s_mov_b32 s12, 0
    buffer_load_dword v2, v12, s[56:59], s69 offen
    s_waitcnt vmcnt(0)
    v_readfirstlane_b32 s10, v2
    s_cmp_eq_u32 s10, 1
    s_cbranch_scc1 PDD_52
PD_51:
    buffer_load_dword v2, v12, s[56:59], s69 offen sc1
    s_waitcnt vmcnt(0)
    v_readfirstlane_b32 s10, v2
    s_cmp_eq_u32 s10, 1
    s_cbranch_scc1 PDD_52
    s_add_u32 s12, s12, 1
    s_cmp_gt_u32 s12, 4194304
    s_cbranch_scc1 DONE
    s_sleep 64
    s_branch PD_51
PDD_52:
    v_mov_b32 v2, 1
    s_mov_b64 exec, 1
    buffer_atomic_add v2, v12, s[52:55], s68 offen sc1
    s_mov_b64 exec, -1
    s_mov_b32 s12, 0
LW_53:
    ds_read_b32 v2, v12 offset:4172
    s_waitcnt lgkmcnt(0)
    v_readfirstlane_b32 s10, v2
    s_cmp_ge_u32 s10, 7
    s_cbranch_scc1 LWD_54
    s_add_u32 s12, s12, 1
    s_cmp_gt_u32 s12, 4194304
    s_cbranch_scc1 DONE
    s_sleep 16
    s_branch LW_53
LWD_54:
    s_mov_b32 s12, 0
PD_55:
    buffer_load_dword v2, v12, s[52:55], s68 offen sc1
    s_waitcnt vmcnt(0)
    v_readfirstlane_b32 s10, v2
    s_cmp_eq_u32 s10, 4
    s_cbranch_scc1 PDD_56
    s_add_u32 s12, s12, 1
    s_cmp_gt_u32 s12, 4194304
    s_cbranch_scc1 DONE
    s_sleep 32
    s_branch PD_55
PDD_56:
    buffer_load_dwordx4 v[52:55], v19, s[52:55], s66 offen sc1
    s_waitcnt vmcnt(0)
    ds_write_b128 v19, v[52:55] offset:4352
    s_waitcnt lgkmcnt(0)
    v_mov_b32 v2, 1
    s_mov_b64 exec, 1
    ds_write_b32 v12, v2 offset:4160
    s_mov_b64 exec, -1
    s_branch H_SET_B
H_SET_B:
    s_mov_b32 s12, 0
LW_57:
    ds_read_b32 v2, v12 offset:4172
    s_waitcnt lgkmcnt(0)
    v_readfirstlane_b32 s10, v2
    s_cmp_ge_u32 s10, 5
    s_cbranch_scc1 LWD_58
    s_add_u32 s12, s12, 1
    s_cmp_gt_u32 s12, 4194304
    s_cbranch_scc1 DONE
    s_sleep 16
    s_branch LW_57
LWD_58:
    s_mov_b32 s9, 0
    s_mov_b32 s48, s34
    s_mov_b32 s49, s35
    s_mov_b32 s50, 0x400000
    s_mov_b32 s51, 0x20000
    s_lshl_b32 s43, s6, 17
H_FIRST:
    s_lshl_b32 s10, s13, 8
    s_add_u32 s43, s43, s10
    s_movk_i32 s15, 0x1000
    v_mov_b32 v36, 0
    v_mov_b32 v37, 0
    v_mov_b32 v38, 0
    v_mov_b32 v39, 0
    v_mov_b32 v40, 0
    v_mov_b32 v41, 0
    v_mov_b32 v42, 0
    v_mov_b32 v43, 0
H_PHASE:
    s_cmp_eq_u32 s9, 0
    s_cbranch_scc1 H_WGLB
    s_mov_b32 s12, 0
LW_59:
    ds_read_b32 v2, v12 offset:4180
    s_waitcnt lgkmcnt(0)
    v_readfirstlane_b32 s10, v2
    s_cmp_eq_u32 s10, 2
    s_cbranch_scc1 LWD_60
    s_add_u32 s12, s12, 1
    s_cmp_gt_u32 s12, 4194304
    s_cbranch_scc1 DONE
    s_sleep 16
    s_branch LW_59
LWD_60:
    s_lshl_b32 s10, s13, 15
    s_add_u32 s10, s10, 16384
    v_add_u32 v2, s10, v19
    ds_read_b128 v[116:119], v2 offset:0
    ds_read_b128 v[120:123], v2 offset:1024
    ds_read_b128 v[124:127], v2 offset:2048
    ds_read_b128 v[128:131], v2 offset:3072
    ds_read_b128 v[132:135], v2 offset:4096
    ds_read_b128 v[136:139], v2 offset:5120
    ds_read_b128 v[140:143], v2 offset:6144
    ds_read_b128 v[144:147], v2 offset:7168
    ds_read_b128 v[148:151], v2 offset:8192
    ds_read_b128 v[152:155], v2 offset:9216
    ds_read_b128 v[156:159], v2 offset:10240
    ds_read_b128 v[160:163], v2 offset:11264
    ds_read_b128 v[164:167], v2 offset:12288
    ds_read_b128 v[168:171], v2 offset:13312
    ds_read_b128 v[172:175], v2 offset:14336
    ds_read_b128 v[176:179], v2 offset:15360
    ds_read_b128 v[180:183], v2 offset:16384
    ds_read_b128 v[184:187], v2 offset:17408
    ds_read_b128 v[188:191], v2 offset:18432
    ds_read_b128 v[192:195], v2 offset:19456
    ds_read_b128 v[196:199], v2 offset:20480
    ds_read_b128 v[200:203], v2 offset:21504
    ds_read_b128 v[204:207], v2 offset:22528
    ds_read_b128 v[208:211], v2 offset:23552
    ds_read_b128 v[212:215], v2 offset:24576
    ds_read_b128 v[216:219], v2 offset:25600
    ds_read_b128 v[220:223], v2 offset:26624
    ds_read_b128 v[224:227], v2 offset:27648
    ds_read_b128 v[228:231], v2 offset:28672
    ds_read_b128 v[232:235], v2 offset:29696
    ds_read_b128 v[236:239], v2 offset:30720
    ds_read_b128 v[240:243], v2 offset:31744
    s_waitcnt lgkmcnt(0)
    s_branch H_WDONE
H_WGLB:
    buffer_load_dwordx4 v[116:119], v14, s[48:51], s43 offen nt
    s_add_u32 s43, s43, s15
    buffer_load_dwordx4 v[120:123], v14, s[48:51], s43 offen nt
    s_add_u32 s43, s43, s15
    s_waitcnt vmcnt(1)
    buffer_load_dwordx4 v[124:127], v14, s[48:51], s43 offen nt
    s_add_u32 s43, s43, s15
    s_waitcnt vmcnt(1)
    buffer_load_dwordx4 v[128:131], v14, s[48:51], s43 offen nt
    s_add_u32 s43, s43, s15
    s_waitcnt vmcnt(1)
    buffer_load_dwordx4 v[132:135], v14, s[48:51], s43 offen nt
    s_add_u32 s43, s43, s15
    s_waitcnt vmcnt(1)
    buffer_load_dwordx4 v[136:139], v14, s[48:51], s43 offen nt
    s_add_u32 s43, s43, s15
    s_waitcnt vmcnt(1)
    buffer_load_dwordx4 v[140:143], v14, s[48:51], s43 offen nt
    s_add_u32 s43, s43, s15
    s_waitcnt vmcnt(1)
    buffer_load_dwordx4 v[144:147], v14, s[48:51], s43 offen nt
    s_add_u32 s43, s43, s15
    s_waitcnt vmcnt(1)
    buffer_load_dwordx4 v[148:151], v14, s[48:51], s43 offen nt
    s_add_u32 s43, s43, s15
    s_waitcnt vmcnt(1)
    buffer_load_dwordx4 v[152:155], v14, s[48:51], s43 offen nt
    s_add_u32 s43, s43, s15
    s_waitcnt vmcnt(1)
    buffer_load_dwordx4 v[156:159], v14, s[48:51], s43 offen nt
    s_add_u32 s43, s43, s15
    s_waitcnt vmcnt(1)
    buffer_load_dwordx4 v[160:163], v14, s[48:51], s43 offen nt
    s_add_u32 s43, s43, s15
    s_waitcnt vmcnt(1)
    buffer_load_dwordx4 v[164:167], v14, s[48:51], s43 offen nt
    s_add_u32 s43, s43, s15
    s_waitcnt vmcnt(1)
    buffer_load_dwordx4 v[168:171], v14, s[48:51], s43 offen nt
    s_add_u32 s43, s43, s15
    s_waitcnt vmcnt(1)
    buffer_load_dwordx4 v[172:175], v14, s[48:51], s43 offen nt
    s_add_u32 s43, s43, s15
    s_waitcnt vmcnt(1)
    buffer_load_dwordx4 v[176:179], v14, s[48:51], s43 offen nt
    s_add_u32 s43, s43, s15
    s_waitcnt vmcnt(1)
    buffer_load_dwordx4 v[180:183], v14, s[48:51], s43 offen nt
    s_add_u32 s43, s43, s15
    s_waitcnt vmcnt(1)
    buffer_load_dwordx4 v[184:187], v14, s[48:51], s43 offen nt
    s_add_u32 s43, s43, s15
    s_waitcnt vmcnt(1)
    buffer_load_dwordx4 v[188:191], v14, s[48:51], s43 offen nt
    s_add_u32 s43, s43, s15
    s_waitcnt vmcnt(1)
    buffer_load_dwordx4 v[192:195], v14, s[48:51], s43 offen nt
    s_add_u32 s43, s43, s15
    s_waitcnt vmcnt(1)
    buffer_load_dwordx4 v[196:199], v14, s[48:51], s43 offen nt
    s_add_u32 s43, s43, s15
    s_waitcnt vmcnt(1)
    buffer_load_dwordx4 v[200:203], v14, s[48:51], s43 offen nt
    s_add_u32 s43, s43, s15
    s_waitcnt vmcnt(1)
    buffer_load_dwordx4 v[204:207], v14, s[48:51], s43 offen nt
    s_add_u32 s43, s43, s15
    s_waitcnt vmcnt(1)
    buffer_load_dwordx4 v[208:211], v14, s[48:51], s43 offen nt
    s_add_u32 s43, s43, s15
    s_waitcnt vmcnt(1)
    buffer_load_dwordx4 v[212:215], v14, s[48:51], s43 offen nt
    s_add_u32 s43, s43, s15
    s_waitcnt vmcnt(1)
    buffer_load_dwordx4 v[216:219], v14, s[48:51], s43 offen nt
    s_add_u32 s43, s43, s15
    s_waitcnt vmcnt(1)
    buffer_load_dwordx4 v[220:223], v14, s[48:51], s43 offen nt
    s_add_u32 s43, s43, s15
    s_waitcnt vmcnt(1)
    buffer_load_dwordx4 v[224:227], v14, s[48:51], s43 offen nt
    s_add_u32 s43, s43, s15
    s_waitcnt vmcnt(1)
    buffer_load_dwordx4 v[228:231], v14, s[48:51], s43 offen nt
    s_add_u32 s43, s43, s15
    s_waitcnt vmcnt(1)
    buffer_load_dwordx4 v[232:235], v14, s[48:51], s43 offen nt
    s_add_u32 s43, s43, s15
    s_waitcnt vmcnt(1)
    buffer_load_dwordx4 v[236:239], v14, s[48:51], s43 offen nt
    s_add_u32 s43, s43, s15
    s_waitcnt vmcnt(1)
    buffer_load_dwordx4 v[240:243], v14, s[48:51], s43 offen nt
    s_add_u32 s43, s43, s15
H_WDONE:
    s_waitcnt vmcnt(0)
    v_perm_b32 v52, v120, v116, v15
    v_perm_b32 v53, v120, v116, v16
    v_perm_b32 v54, v121, v117, v15
    v_perm_b32 v55, v121, v117, v16
    v_perm_b32 v56, v122, v118, v15
    v_perm_b32 v57, v122, v118, v16
    v_perm_b32 v58, v123, v119, v15
    v_perm_b32 v59, v123, v119, v16
    v_pk_mov_b32 v[116:117], v[52:53], v[52:53] op_sel:[0,1]
    v_pk_mov_b32 v[118:119], v[54:55], v[54:55] op_sel:[0,1]
    v_pk_mov_b32 v[120:121], v[56:57], v[56:57] op_sel:[0,1]
    v_pk_mov_b32 v[122:123], v[58:59], v[58:59] op_sel:[0,1]
    v_perm_b32 v52, v128, v124, v15
    v_perm_b32 v53, v128, v124, v16
    v_perm_b32 v54, v129, v125, v15
    v_perm_b32 v55, v129, v125, v16
    v_perm_b32 v56, v130, v126, v15
    v_perm_b32 v57, v130, v126, v16
    v_perm_b32 v58, v131, v127, v15
    v_perm_b32 v59, v131, v127, v16
    v_pk_mov_b32 v[124:125], v[52:53], v[52:53] op_sel:[0,1]
    v_pk_mov_b32 v[126:127], v[54:55], v[54:55] op_sel:[0,1]
    v_pk_mov_b32 v[128:129], v[56:57], v[56:57] op_sel:[0,1]
    v_pk_mov_b32 v[130:131], v[58:59], v[58:59] op_sel:[0,1]
    v_perm_b32 v52, v136, v132, v15
    v_perm_b32 v53, v136, v132, v16
    v_perm_b32 v54, v137, v133, v15
    v_perm_b32 v55, v137, v133, v16
    v_perm_b32 v56, v138, v134, v15
    v_perm_b32 v57, v138, v134, v16
    v_perm_b32 v58, v139, v135, v15
    v_perm_b32 v59, v139, v135, v16
    v_pk_mov_b32 v[132:133], v[52:53], v[52:53] op_sel:[0,1]
    v_pk_mov_b32 v[134:135], v[54:55], v[54:55] op_sel:[0,1]
    v_pk_mov_b32 v[136:137], v[56:57], v[56:57] op_sel:[0,1]
    v_pk_mov_b32 v[138:139], v[58:59], v[58:59] op_sel:[0,1]
    v_perm_b32 v52, v144, v140, v15
    v_perm_b32 v53, v144, v140, v16
    v_perm_b32 v54, v145, v141, v15
    v_perm_b32 v55, v145, v141, v16
    v_perm_b32 v56, v146, v142, v15
    v_perm_b32 v57, v146, v142, v16
    v_perm_b32 v58, v147, v143, v15
    v_perm_b32 v59, v147, v143, v16
    v_pk_mov_b32 v[140:141], v[52:53], v[52:53] op_sel:[0,1]
    v_pk_mov_b32 v[142:143], v[54:55], v[54:55] op_sel:[0,1]
    v_pk_mov_b32 v[144:145], v[56:57], v[56:57] op_sel:[0,1]
    v_pk_mov_b32 v[146:147], v[58:59], v[58:59] op_sel:[0,1]
    v_perm_b32 v52, v152, v148, v15
    v_perm_b32 v53, v152, v148, v16
    v_perm_b32 v54, v153, v149, v15
    v_perm_b32 v55, v153, v149, v16
    v_perm_b32 v56, v154, v150, v15
    v_perm_b32 v57, v154, v150, v16
    v_perm_b32 v58, v155, v151, v15
    v_perm_b32 v59, v155, v151, v16
    v_pk_mov_b32 v[148:149], v[52:53], v[52:53] op_sel:[0,1]
    v_pk_mov_b32 v[150:151], v[54:55], v[54:55] op_sel:[0,1]
    v_pk_mov_b32 v[152:153], v[56:57], v[56:57] op_sel:[0,1]
    v_pk_mov_b32 v[154:155], v[58:59], v[58:59] op_sel:[0,1]
    v_perm_b32 v52, v160, v156, v15
    v_perm_b32 v53, v160, v156, v16
    v_perm_b32 v54, v161, v157, v15
    v_perm_b32 v55, v161, v157, v16
    v_perm_b32 v56, v162, v158, v15
    v_perm_b32 v57, v162, v158, v16
    v_perm_b32 v58, v163, v159, v15
    v_perm_b32 v59, v163, v159, v16
    v_pk_mov_b32 v[156:157], v[52:53], v[52:53] op_sel:[0,1]
    v_pk_mov_b32 v[158:159], v[54:55], v[54:55] op_sel:[0,1]
    v_pk_mov_b32 v[160:161], v[56:57], v[56:57] op_sel:[0,1]
    v_pk_mov_b32 v[162:163], v[58:59], v[58:59] op_sel:[0,1]
    v_perm_b32 v52, v168, v164, v15
    v_perm_b32 v53, v168, v164, v16
    v_perm_b32 v54, v169, v165, v15
    v_perm_b32 v55, v169, v165, v16
    v_perm_b32 v56, v170, v166, v15
    v_perm_b32 v57, v170, v166, v16
    v_perm_b32 v58, v171, v167, v15
    v_perm_b32 v59, v171, v167, v16
    v_pk_mov_b32 v[164:165], v[52:53], v[52:53] op_sel:[0,1]
    v_pk_mov_b32 v[166:167], v[54:55], v[54:55] op_sel:[0,1]
    v_pk_mov_b32 v[168:169], v[56:57], v[56:57] op_sel:[0,1]
    v_pk_mov_b32 v[170:171], v[58:59], v[58:59] op_sel:[0,1]
    v_perm_b32 v52, v176, v172, v15
    v_perm_b32 v53, v176, v172, v16
    v_perm_b32 v54, v177, v173, v15
    v_perm_b32 v55, v177, v173, v16
    v_perm_b32 v56, v178, v174, v15
    v_perm_b32 v57, v178, v174, v16
    v_perm_b32 v58, v179, v175, v15
    v_perm_b32 v59, v179, v175, v16
    v_pk_mov_b32 v[172:173], v[52:53], v[52:53] op_sel:[0,1]
    v_pk_mov_b32 v[174:175], v[54:55], v[54:55] op_sel:[0,1]
    v_pk_mov_b32 v[176:177], v[56:57], v[56:57] op_sel:[0,1]
    v_pk_mov_b32 v[178:179], v[58:59], v[58:59] op_sel:[0,1]
    v_perm_b32 v52, v184, v180, v15
    v_perm_b32 v53, v184, v180, v16
    v_perm_b32 v54, v185, v181, v15
    v_perm_b32 v55, v185, v181, v16
    v_perm_b32 v56, v186, v182, v15
    v_perm_b32 v57, v186, v182, v16
    v_perm_b32 v58, v187, v183, v15
    v_perm_b32 v59, v187, v183, v16
    v_pk_mov_b32 v[180:181], v[52:53], v[52:53] op_sel:[0,1]
    v_pk_mov_b32 v[182:183], v[54:55], v[54:55] op_sel:[0,1]
    v_pk_mov_b32 v[184:185], v[56:57], v[56:57] op_sel:[0,1]
    v_pk_mov_b32 v[186:187], v[58:59], v[58:59] op_sel:[0,1]
    v_perm_b32 v52, v192, v188, v15
    v_perm_b32 v53, v192, v188, v16
    v_perm_b32 v54, v193, v189, v15
    v_perm_b32 v55, v193, v189, v16
    v_perm_b32 v56, v194, v190, v15
    v_perm_b32 v57, v194, v190, v16
    v_perm_b32 v58, v195, v191, v15
    v_perm_b32 v59, v195, v191, v16
    v_pk_mov_b32 v[188:189], v[52:53], v[52:53] op_sel:[0,1]
    v_pk_mov_b32 v[190:191], v[54:55], v[54:55] op_sel:[0,1]
    v_pk_mov_b32 v[192:193], v[56:57], v[56:57] op_sel:[0,1]
    v_pk_mov_b32 v[194:195], v[58:59], v[58:59] op_sel:[0,1]
    v_perm_b32 v52, v200, v196, v15
    v_perm_b32 v53, v200, v196, v16
    v_perm_b32 v54, v201, v197, v15
    v_perm_b32 v55, v201, v197, v16
    v_perm_b32 v56, v202, v198, v15
    v_perm_b32 v57, v202, v198, v16
    v_perm_b32 v58, v203, v199, v15
    v_perm_b32 v59, v203, v199, v16
    v_pk_mov_b32 v[196:197], v[52:53], v[52:53] op_sel:[0,1]
    v_pk_mov_b32 v[198:199], v[54:55], v[54:55] op_sel:[0,1]
    v_pk_mov_b32 v[200:201], v[56:57], v[56:57] op_sel:[0,1]
    v_pk_mov_b32 v[202:203], v[58:59], v[58:59] op_sel:[0,1]
    v_perm_b32 v52, v208, v204, v15
    v_perm_b32 v53, v208, v204, v16
    v_perm_b32 v54, v209, v205, v15
    v_perm_b32 v55, v209, v205, v16
    v_perm_b32 v56, v210, v206, v15
    v_perm_b32 v57, v210, v206, v16
    v_perm_b32 v58, v211, v207, v15
    v_perm_b32 v59, v211, v207, v16
    v_pk_mov_b32 v[204:205], v[52:53], v[52:53] op_sel:[0,1]
    v_pk_mov_b32 v[206:207], v[54:55], v[54:55] op_sel:[0,1]
    v_pk_mov_b32 v[208:209], v[56:57], v[56:57] op_sel:[0,1]
    v_pk_mov_b32 v[210:211], v[58:59], v[58:59] op_sel:[0,1]
    v_perm_b32 v52, v216, v212, v15
    v_perm_b32 v53, v216, v212, v16
    v_perm_b32 v54, v217, v213, v15
    v_perm_b32 v55, v217, v213, v16
    v_perm_b32 v56, v218, v214, v15
    v_perm_b32 v57, v218, v214, v16
    v_perm_b32 v58, v219, v215, v15
    v_perm_b32 v59, v219, v215, v16
    v_pk_mov_b32 v[212:213], v[52:53], v[52:53] op_sel:[0,1]
    v_pk_mov_b32 v[214:215], v[54:55], v[54:55] op_sel:[0,1]
    v_pk_mov_b32 v[216:217], v[56:57], v[56:57] op_sel:[0,1]
    v_pk_mov_b32 v[218:219], v[58:59], v[58:59] op_sel:[0,1]
    v_perm_b32 v52, v224, v220, v15
    v_perm_b32 v53, v224, v220, v16
    v_perm_b32 v54, v225, v221, v15
    v_perm_b32 v55, v225, v221, v16
    v_perm_b32 v56, v226, v222, v15
    v_perm_b32 v57, v226, v222, v16
    v_perm_b32 v58, v227, v223, v15
    v_perm_b32 v59, v227, v223, v16
    v_pk_mov_b32 v[220:221], v[52:53], v[52:53] op_sel:[0,1]
    v_pk_mov_b32 v[222:223], v[54:55], v[54:55] op_sel:[0,1]
    v_pk_mov_b32 v[224:225], v[56:57], v[56:57] op_sel:[0,1]
    v_pk_mov_b32 v[226:227], v[58:59], v[58:59] op_sel:[0,1]
    v_perm_b32 v52, v232, v228, v15
    v_perm_b32 v53, v232, v228, v16
    v_perm_b32 v54, v233, v229, v15
    v_perm_b32 v55, v233, v229, v16
    v_perm_b32 v56, v234, v230, v15
    v_perm_b32 v57, v234, v230, v16
    v_perm_b32 v58, v235, v231, v15
    v_perm_b32 v59, v235, v231, v16
    v_pk_mov_b32 v[228:229], v[52:53], v[52:53] op_sel:[0,1]
    v_pk_mov_b32 v[230:231], v[54:55], v[54:55] op_sel:[0,1]
    v_pk_mov_b32 v[232:233], v[56:57], v[56:57] op_sel:[0,1]
    v_pk_mov_b32 v[234:235], v[58:59], v[58:59] op_sel:[0,1]
    v_perm_b32 v52, v240, v236, v15
    v_perm_b32 v53, v240, v236, v16
    v_perm_b32 v54, v241, v237, v15
    v_perm_b32 v55, v241, v237, v16
    v_perm_b32 v56, v242, v238, v15
    v_perm_b32 v57, v242, v238, v16
    v_perm_b32 v58, v243, v239, v15
    v_perm_b32 v59, v243, v239, v16
    v_pk_mov_b32 v[236:237], v[52:53], v[52:53] op_sel:[0,1]
    v_pk_mov_b32 v[238:239], v[54:55], v[54:55] op_sel:[0,1]
    v_pk_mov_b32 v[240:241], v[56:57], v[56:57] op_sel:[0,1]
    v_pk_mov_b32 v[242:243], v[58:59], v[58:59] op_sel:[0,1]
    s_cmp_eq_u32 s9, 1
    s_cbranch_scc1 H_IN_A
    s_cmp_lg_u32 s13, 1
    s_cbranch_scc1 H_WAITGO
    s_mov_b32 s12, 0
LW_61:
    ds_read_b32 v2, v12 offset:4164
    s_waitcnt lgkmcnt(0)
    v_readfirstlane_b32 s10, v2
    s_cmp_eq_u32 s10, 4
    s_cbranch_scc1 LWD_62
    s_add_u32 s12, s12, 1
    s_cmp_gt_u32 s12, 4194304
    s_cbranch_scc1 DONE
    s_sleep 16
    s_branch LW_61
LWD_62:
    v_lshlrev_b32 v2, 5, v4
    ds_read_b128 v[52:55], v2 offset:13824
    ds_read_b128 v[56:59], v2 offset:13840
    ds_read_b128 v[60:63], v18 offset:5632
    ds_read_b128 v[64:67], v18 offset:5648
    ds_read_b128 v[68:71], v18 offset:7680
    ds_read_b128 v[72:75], v18 offset:7696
    ds_read_b128 v[76:79], v18 offset:9728
    ds_read_b128 v[80:83], v18 offset:9744
    ds_read_b128 v[84:87], v18 offset:11776
    ds_read_b128 v[88:91], v18 offset:11792
    s_waitcnt lgkmcnt(0)
    v_max3_f32 v48, v52, v54, v56
    v_max_f32 v48, v48, v58
    v_sub_f32 v44, v52, v48
    v_sub_f32 v45, v54, v48
    v_sub_f32 v46, v56, v48
    v_sub_f32 v47, v58, v48
    v_exp_f32 v44, v44
    v_exp_f32 v45, v45
    v_exp_f32 v46, v46
    v_exp_f32 v47, v47
    s_nop 0
    v_mul_f32 v49, v44, v53
    v_fmac_f32 v49, v45, v55
    v_fmac_f32 v49, v46, v57
    v_fmac_f32 v49, v47, v59
    v_mul_f32 v36, v44, v60
    v_mul_f32 v37, v44, v61
    v_mul_f32 v38, v44, v62
    v_mul_f32 v39, v44, v63
    v_mul_f32 v40, v44, v64
    v_mul_f32 v41, v44, v65
    v_mul_f32 v42, v44, v66
    v_mul_f32 v43, v44, v67
    v_fmac_f32 v36, v45, v68
    v_fmac_f32 v37, v45, v69
    v_fmac_f32 v38, v45, v70
    v_fmac_f32 v39, v45, v71
    v_fmac_f32 v40, v45, v72
    v_fmac_f32 v41, v45, v73
    v_fmac_f32 v42, v45, v74
    v_fmac_f32 v43, v45, v75
    v_fmac_f32 v36, v46, v76
    v_fmac_f32 v37, v46, v77
    v_fmac_f32 v38, v46, v78
    v_fmac_f32 v39, v46, v79
    v_fmac_f32 v40, v46, v80
    v_fmac_f32 v41, v46, v81
    v_fmac_f32 v42, v46, v82
    v_fmac_f32 v43, v46, v83
    v_fmac_f32 v36, v47, v84
    v_fmac_f32 v37, v47, v85
    v_fmac_f32 v38, v47, v86
    v_fmac_f32 v39, v47, v87
    v_fmac_f32 v40, v47, v88
    v_fmac_f32 v41, v47, v89
    v_fmac_f32 v42, v47, v90
    v_fmac_f32 v43, v47, v91
    s_mul_i32 s11, s5, 2176
    s_add_u32 s11, s11, s65
    s_lshl_b32 s10, s5, 4
    s_mov_b64 s[42:43], 0xffff
    s_lshl_b64 s[42:43], s[42:43], s10
    v_lshlrev_b32 v2, 5, v5
    s_mov_b64 exec, s[42:43]
    ds_write_b128 v2, v[36:39] offset:1536
    ds_write_b128 v2, v[40:43] offset:1552
    ds_write_b64 v12, v[48:49] offset:4152
    s_not_b64 exec, s[42:43]
    buffer_store_dwordx4 v[36:39], v19, s[52:55], s11 offen sc1
    buffer_store_dwordx4 v[40:43], v19, s[52:55], s11 offen offset:1024 sc1
    s_mov_b64 exec, -1
    v_lshrrev_b32 v9, 3, v0
    v_lshlrev_b32 v9, 12, v9
    v_and_b32 v3, 7, v0
    v_lshl_add_u32 v9, v3, 4, v9
    s_add_u32 s10, s71, 0
    buffer_load_dwordx4 v[100:103], v9, s[52:55], s10 offen sc1 nt
    s_add_u32 s10, s71, 32768
    buffer_load_dwordx4 v[104:107], v9, s[52:55], s10 offen sc1 nt
    s_add_u32 s10, s71, 65536
    buffer_load_dwordx4 v[108:111], v9, s[52:55], s10 offen sc1 nt
    s_add_u32 s10, s71, 98304
    buffer_load_dwordx4 v[112:115], v9, s[52:55], s10 offen sc1 nt
    v_lshlrev_b32 v2, 3, v4
    s_mov_b32 exec_lo, 0x10001
    s_mov_b32 exec_hi, 0x10001
    buffer_store_dwordx2 v[48:49], v2, s[52:55], s11 offen offset:2048 sc1
    s_mov_b64 exec, -1
    s_waitcnt vmcnt(0)
    v_mov_b32 v2, 1
    s_mov_b64 exec, 1
    buffer_atomic_add v2, v12, s[52:55], s73 offen sc0 sc1
    s_mov_b64 exec, -1
    v_not_b32 v100, v100
    v_not_b32 v101, v101
    v_not_b32 v102, v102
    v_not_b32 v103, v103
    v_not_b32 v104, v104
    v_not_b32 v105, v105
    v_not_b32 v106, v106
    v_not_b32 v107, v107
    v_not_b32 v108, v108
    v_not_b32 v109, v109
    v_not_b32 v110, v110
    v_not_b32 v111, v111
    v_not_b32 v112, v112
    v_not_b32 v113, v113
    v_not_b32 v114, v114
    v_not_b32 v115, v115
    s_waitcnt vmcnt(0)
    v_readfirstlane_b32 s10, v2
    s_cmp_lt_u32 s10, 10
    s_cselect_b32 s11, 1, 0
    s_cmp_ge_u32 s10, 22
    s_cselect_b32 s11, 2, s11
    v_mov_b32 v2, s11
    s_mov_b64 exec, 1
    ds_write_b32 v12, v2 offset:4168
    s_mov_b64 exec, -1
    s_mov_b32 s12, 0
LW_63:
    ds_read_b32 v2, v12 offset:4172
    s_waitcnt lgkmcnt(0)
    v_readfirstlane_b32 s10, v2
    s_cmp_ge_u32 s10, 13
    s_cbranch_scc1 LWD_64
    s_add_u32 s12, s12, 1
    s_cmp_gt_u32 s12, 4194304
    s_cbranch_scc1 DONE
    s_sleep 16
    s_branch LW_63
LWD_64:
    s_mov_b32 s12, 0
PD_65:
    buffer_load_dword v2, v12, s[52:55], s73 offen sc1
    s_waitcnt vmcnt(0)
    v_readfirstlane_b32 s10, v2
    s_cmp_eq_u32 s10, 32
    s_cbranch_scc1 PDD_66
    s_add_u32 s12, s12, 1
    s_cmp_gt_u32 s12, 4194304
    s_cbranch_scc1 DONE
    s_sleep 64
    s_branch PD_65
PDD_66:
    s_add_u32 s10, s5, 1
    v_add_u32 v2, s10, v4
    v_and_b32 v2, 3, v2
    v_mul_u32_u24 v2, 2176, v2
    v_lshl_add_u32 v3, v5, 4, v2
    s_lshl_b32 s10, s5, 8
    s_add_u32 s10, s10, s65
    s_lshl_b32 s11, s5, 3
    s_add_u32 s11, s11, s65
    s_mov_b32 exec_hi, 0xffff
    buffer_load_dwordx4 v[60:63], v3, s[52:55], s10 offen sc1
    buffer_load_dwordx4 v[64:67], v3, s[52:55], s10 offen offset:1024 sc1
    buffer_load_dwordx2 v[52:53], v2, s[52:55], s11 offen offset:2048 sc1
    v_lshlrev_b32 v2, 3, v4
    s_waitcnt vmcnt(0)
    ds_write_b128 v18, v[60:63] offset:0
    ds_write_b128 v18, v[64:67] offset:16
    ds_write_b64 v2, v[52:53] offset:4128
    s_mov_b64 exec, -1
    s_waitcnt lgkmcnt(0)
    v_mov_b32 v2, 1
    s_mov_b64 exec, 1
    ds_write_b32 v12, v2 offset:4176
    s_mov_b64 exec, -1
H_WAITGO:
    s_mov_b32 s12, 0
LW_67:
    ds_read_b32 v2, v12 offset:4176
    s_waitcnt lgkmcnt(0)
    v_readfirstlane_b32 s10, v2
    s_cmp_eq_u32 s10, 1
    s_cbranch_scc1 LWD_68
    s_add_u32 s12, s12, 1
    s_cmp_gt_u32 s12, 4194304
    s_cbranch_scc1 DONE
    s_sleep 16
    s_branch LW_67
LWD_68:
    v_mov_b32 v36, 0
    v_mov_b32 v37, 0
    v_mov_b32 v38, 0
    v_mov_b32 v39, 0
    v_mov_b32 v40, 0
    v_mov_b32 v41, 0
    v_mov_b32 v42, 0
    v_mov_b32 v43, 0
    v_add_u32 v3, 0, v13
    v_add_u32 v2, 1024, v13
    v_mov_b32 v21, 32
    s_branch H_READ
H_IN_A:
    v_add_u32 v3, 2048, v13
    v_add_u32 v2, 3072, v13
    v_mov_b32 v21, 0
    v_not_b32 v28, v28
    v_not_b32 v29, v29
    v_not_b32 v30, v30
    v_not_b32 v31, v31
    s_barrier
H_READ:
    ds_read_b128 v[52:55], v21 offset:4096
    ds_read_b128 v[56:59], v21 offset:4112
    ds_read2_b32 v[60:61], v3 offset0:0 offset1:4
    ds_read2_b32 v[62:63], v3 offset0:128 offset1:132
    ds_read2_b32 v[64:65], v2 offset0:0 offset1:4
    ds_read2_b32 v[66:67], v2 offset0:128 offset1:132
    s_waitcnt lgkmcnt(0)
H_PROJ:
    v_max3_f32 v48, v52, v54, v56
    v_max_f32 v48, v48, v58
    v_sub_f32 v44, v52, v48
    v_sub_f32 v45, v54, v48
    v_sub_f32 v46, v56, v48
    v_sub_f32 v47, v58, v48
    v_exp_f32 v44, v44
    v_exp_f32 v45, v45
    v_exp_f32 v46, v46
    v_exp_f32 v47, v47
    s_nop 0
    v_mul_f32 v49, v44, v53
    v_fmac_f32 v49, v45, v55
    v_fmac_f32 v49, v46, v57
    v_fmac_f32 v49, v47, v59
    v_mul_f32 v50, v44, v60
    v_mul_f32 v51, v44, v61
    v_rcp_f32 v49, v49
    v_fmac_f32 v50, v45, v62
    v_fmac_f32 v51, v45, v63
    v_fmac_f32 v50, v46, v64
    v_fmac_f32 v51, v46, v65
    v_fmac_f32 v50, v47, v66
    v_fmac_f32 v51, v47, v67
    v_mul_f32 v50, v50, v49
    v_mul_f32 v51, v51, v49
    v_cvt_pk_bf16_f32 v20, v50, v51
    s_nop 1
    v_dot2c_f32_bf16_dpp v36, v20, v116 row_newbcast:0 row_mask:0xf bank_mask:0xf
    v_dot2c_f32_bf16_dpp v37, v20, v117 row_newbcast:0 row_mask:0xf bank_mask:0xf
    v_dot2c_f32_bf16_dpp v38, v20, v118 row_newbcast:0 row_mask:0xf bank_mask:0xf
    v_dot2c_f32_bf16_dpp v39, v20, v119 row_newbcast:0 row_mask:0xf bank_mask:0xf
    v_dot2c_f32_bf16_dpp v40, v20, v120 row_newbcast:0 row_mask:0xf bank_mask:0xf
    v_dot2c_f32_bf16_dpp v41, v20, v121 row_newbcast:0 row_mask:0xf bank_mask:0xf
    v_dot2c_f32_bf16_dpp v42, v20, v122 row_newbcast:0 row_mask:0xf bank_mask:0xf
    v_dot2c_f32_bf16_dpp v43, v20, v123 row_newbcast:0 row_mask:0xf bank_mask:0xf
    v_dot2c_f32_bf16_dpp v36, v20, v124 row_newbcast:1 row_mask:0xf bank_mask:0xf
    v_dot2c_f32_bf16_dpp v37, v20, v125 row_newbcast:1 row_mask:0xf bank_mask:0xf
    v_dot2c_f32_bf16_dpp v38, v20, v126 row_newbcast:1 row_mask:0xf bank_mask:0xf
    v_dot2c_f32_bf16_dpp v39, v20, v127 row_newbcast:1 row_mask:0xf bank_mask:0xf
    v_dot2c_f32_bf16_dpp v40, v20, v128 row_newbcast:1 row_mask:0xf bank_mask:0xf
    v_dot2c_f32_bf16_dpp v41, v20, v129 row_newbcast:1 row_mask:0xf bank_mask:0xf
    v_dot2c_f32_bf16_dpp v42, v20, v130 row_newbcast:1 row_mask:0xf bank_mask:0xf
    v_dot2c_f32_bf16_dpp v43, v20, v131 row_newbcast:1 row_mask:0xf bank_mask:0xf
    v_dot2c_f32_bf16_dpp v36, v20, v132 row_newbcast:2 row_mask:0xf bank_mask:0xf
    v_dot2c_f32_bf16_dpp v37, v20, v133 row_newbcast:2 row_mask:0xf bank_mask:0xf
    v_dot2c_f32_bf16_dpp v38, v20, v134 row_newbcast:2 row_mask:0xf bank_mask:0xf
    v_dot2c_f32_bf16_dpp v39, v20, v135 row_newbcast:2 row_mask:0xf bank_mask:0xf
    v_dot2c_f32_bf16_dpp v40, v20, v136 row_newbcast:2 row_mask:0xf bank_mask:0xf
    v_dot2c_f32_bf16_dpp v41, v20, v137 row_newbcast:2 row_mask:0xf bank_mask:0xf
    v_dot2c_f32_bf16_dpp v42, v20, v138 row_newbcast:2 row_mask:0xf bank_mask:0xf
    v_dot2c_f32_bf16_dpp v43, v20, v139 row_newbcast:2 row_mask:0xf bank_mask:0xf
    v_dot2c_f32_bf16_dpp v36, v20, v140 row_newbcast:3 row_mask:0xf bank_mask:0xf
    v_dot2c_f32_bf16_dpp v37, v20, v141 row_newbcast:3 row_mask:0xf bank_mask:0xf
    v_dot2c_f32_bf16_dpp v38, v20, v142 row_newbcast:3 row_mask:0xf bank_mask:0xf
    v_dot2c_f32_bf16_dpp v39, v20, v143 row_newbcast:3 row_mask:0xf bank_mask:0xf
    v_dot2c_f32_bf16_dpp v40, v20, v144 row_newbcast:3 row_mask:0xf bank_mask:0xf
    v_dot2c_f32_bf16_dpp v41, v20, v145 row_newbcast:3 row_mask:0xf bank_mask:0xf
    v_dot2c_f32_bf16_dpp v42, v20, v146 row_newbcast:3 row_mask:0xf bank_mask:0xf
    v_dot2c_f32_bf16_dpp v43, v20, v147 row_newbcast:3 row_mask:0xf bank_mask:0xf
    v_dot2c_f32_bf16_dpp v36, v20, v148 row_newbcast:4 row_mask:0xf bank_mask:0xf
    v_dot2c_f32_bf16_dpp v37, v20, v149 row_newbcast:4 row_mask:0xf bank_mask:0xf
    v_dot2c_f32_bf16_dpp v38, v20, v150 row_newbcast:4 row_mask:0xf bank_mask:0xf
    v_dot2c_f32_bf16_dpp v39, v20, v151 row_newbcast:4 row_mask:0xf bank_mask:0xf
    v_dot2c_f32_bf16_dpp v40, v20, v152 row_newbcast:4 row_mask:0xf bank_mask:0xf
    v_dot2c_f32_bf16_dpp v41, v20, v153 row_newbcast:4 row_mask:0xf bank_mask:0xf
    v_dot2c_f32_bf16_dpp v42, v20, v154 row_newbcast:4 row_mask:0xf bank_mask:0xf
    v_dot2c_f32_bf16_dpp v43, v20, v155 row_newbcast:4 row_mask:0xf bank_mask:0xf
    v_dot2c_f32_bf16_dpp v36, v20, v156 row_newbcast:5 row_mask:0xf bank_mask:0xf
    v_dot2c_f32_bf16_dpp v37, v20, v157 row_newbcast:5 row_mask:0xf bank_mask:0xf
    v_dot2c_f32_bf16_dpp v38, v20, v158 row_newbcast:5 row_mask:0xf bank_mask:0xf
    v_dot2c_f32_bf16_dpp v39, v20, v159 row_newbcast:5 row_mask:0xf bank_mask:0xf
    v_dot2c_f32_bf16_dpp v40, v20, v160 row_newbcast:5 row_mask:0xf bank_mask:0xf
    v_dot2c_f32_bf16_dpp v41, v20, v161 row_newbcast:5 row_mask:0xf bank_mask:0xf
    v_dot2c_f32_bf16_dpp v42, v20, v162 row_newbcast:5 row_mask:0xf bank_mask:0xf
    v_dot2c_f32_bf16_dpp v43, v20, v163 row_newbcast:5 row_mask:0xf bank_mask:0xf
    v_dot2c_f32_bf16_dpp v36, v20, v164 row_newbcast:6 row_mask:0xf bank_mask:0xf
    v_dot2c_f32_bf16_dpp v37, v20, v165 row_newbcast:6 row_mask:0xf bank_mask:0xf
    v_dot2c_f32_bf16_dpp v38, v20, v166 row_newbcast:6 row_mask:0xf bank_mask:0xf
    v_dot2c_f32_bf16_dpp v39, v20, v167 row_newbcast:6 row_mask:0xf bank_mask:0xf
    v_dot2c_f32_bf16_dpp v40, v20, v168 row_newbcast:6 row_mask:0xf bank_mask:0xf
    v_dot2c_f32_bf16_dpp v41, v20, v169 row_newbcast:6 row_mask:0xf bank_mask:0xf
    v_dot2c_f32_bf16_dpp v42, v20, v170 row_newbcast:6 row_mask:0xf bank_mask:0xf
    v_dot2c_f32_bf16_dpp v43, v20, v171 row_newbcast:6 row_mask:0xf bank_mask:0xf
    v_dot2c_f32_bf16_dpp v36, v20, v172 row_newbcast:7 row_mask:0xf bank_mask:0xf
    v_dot2c_f32_bf16_dpp v37, v20, v173 row_newbcast:7 row_mask:0xf bank_mask:0xf
    v_dot2c_f32_bf16_dpp v38, v20, v174 row_newbcast:7 row_mask:0xf bank_mask:0xf
    v_dot2c_f32_bf16_dpp v39, v20, v175 row_newbcast:7 row_mask:0xf bank_mask:0xf
    v_dot2c_f32_bf16_dpp v40, v20, v176 row_newbcast:7 row_mask:0xf bank_mask:0xf
    v_dot2c_f32_bf16_dpp v41, v20, v177 row_newbcast:7 row_mask:0xf bank_mask:0xf
    v_dot2c_f32_bf16_dpp v42, v20, v178 row_newbcast:7 row_mask:0xf bank_mask:0xf
    v_dot2c_f32_bf16_dpp v43, v20, v179 row_newbcast:7 row_mask:0xf bank_mask:0xf
    v_dot2c_f32_bf16_dpp v36, v20, v180 row_newbcast:8 row_mask:0xf bank_mask:0xf
    v_dot2c_f32_bf16_dpp v37, v20, v181 row_newbcast:8 row_mask:0xf bank_mask:0xf
    v_dot2c_f32_bf16_dpp v38, v20, v182 row_newbcast:8 row_mask:0xf bank_mask:0xf
    v_dot2c_f32_bf16_dpp v39, v20, v183 row_newbcast:8 row_mask:0xf bank_mask:0xf
    v_dot2c_f32_bf16_dpp v40, v20, v184 row_newbcast:8 row_mask:0xf bank_mask:0xf
    v_dot2c_f32_bf16_dpp v41, v20, v185 row_newbcast:8 row_mask:0xf bank_mask:0xf
    v_dot2c_f32_bf16_dpp v42, v20, v186 row_newbcast:8 row_mask:0xf bank_mask:0xf
    v_dot2c_f32_bf16_dpp v43, v20, v187 row_newbcast:8 row_mask:0xf bank_mask:0xf
    v_dot2c_f32_bf16_dpp v36, v20, v188 row_newbcast:9 row_mask:0xf bank_mask:0xf
    v_dot2c_f32_bf16_dpp v37, v20, v189 row_newbcast:9 row_mask:0xf bank_mask:0xf
    v_dot2c_f32_bf16_dpp v38, v20, v190 row_newbcast:9 row_mask:0xf bank_mask:0xf
    v_dot2c_f32_bf16_dpp v39, v20, v191 row_newbcast:9 row_mask:0xf bank_mask:0xf
    v_dot2c_f32_bf16_dpp v40, v20, v192 row_newbcast:9 row_mask:0xf bank_mask:0xf
    v_dot2c_f32_bf16_dpp v41, v20, v193 row_newbcast:9 row_mask:0xf bank_mask:0xf
    v_dot2c_f32_bf16_dpp v42, v20, v194 row_newbcast:9 row_mask:0xf bank_mask:0xf
    v_dot2c_f32_bf16_dpp v43, v20, v195 row_newbcast:9 row_mask:0xf bank_mask:0xf
    v_dot2c_f32_bf16_dpp v36, v20, v196 row_newbcast:10 row_mask:0xf bank_mask:0xf
    v_dot2c_f32_bf16_dpp v37, v20, v197 row_newbcast:10 row_mask:0xf bank_mask:0xf
    v_dot2c_f32_bf16_dpp v38, v20, v198 row_newbcast:10 row_mask:0xf bank_mask:0xf
    v_dot2c_f32_bf16_dpp v39, v20, v199 row_newbcast:10 row_mask:0xf bank_mask:0xf
    v_dot2c_f32_bf16_dpp v40, v20, v200 row_newbcast:10 row_mask:0xf bank_mask:0xf
    v_dot2c_f32_bf16_dpp v41, v20, v201 row_newbcast:10 row_mask:0xf bank_mask:0xf
    v_dot2c_f32_bf16_dpp v42, v20, v202 row_newbcast:10 row_mask:0xf bank_mask:0xf
    v_dot2c_f32_bf16_dpp v43, v20, v203 row_newbcast:10 row_mask:0xf bank_mask:0xf
    v_dot2c_f32_bf16_dpp v36, v20, v204 row_newbcast:11 row_mask:0xf bank_mask:0xf
    v_dot2c_f32_bf16_dpp v37, v20, v205 row_newbcast:11 row_mask:0xf bank_mask:0xf
    v_dot2c_f32_bf16_dpp v38, v20, v206 row_newbcast:11 row_mask:0xf bank_mask:0xf
    v_dot2c_f32_bf16_dpp v39, v20, v207 row_newbcast:11 row_mask:0xf bank_mask:0xf
    v_dot2c_f32_bf16_dpp v40, v20, v208 row_newbcast:11 row_mask:0xf bank_mask:0xf
    v_dot2c_f32_bf16_dpp v41, v20, v209 row_newbcast:11 row_mask:0xf bank_mask:0xf
    v_dot2c_f32_bf16_dpp v42, v20, v210 row_newbcast:11 row_mask:0xf bank_mask:0xf
    v_dot2c_f32_bf16_dpp v43, v20, v211 row_newbcast:11 row_mask:0xf bank_mask:0xf
    v_dot2c_f32_bf16_dpp v36, v20, v212 row_newbcast:12 row_mask:0xf bank_mask:0xf
    v_dot2c_f32_bf16_dpp v37, v20, v213 row_newbcast:12 row_mask:0xf bank_mask:0xf
    v_dot2c_f32_bf16_dpp v38, v20, v214 row_newbcast:12 row_mask:0xf bank_mask:0xf
    v_dot2c_f32_bf16_dpp v39, v20, v215 row_newbcast:12 row_mask:0xf bank_mask:0xf
    v_dot2c_f32_bf16_dpp v40, v20, v216 row_newbcast:12 row_mask:0xf bank_mask:0xf
    v_dot2c_f32_bf16_dpp v41, v20, v217 row_newbcast:12 row_mask:0xf bank_mask:0xf
    v_dot2c_f32_bf16_dpp v42, v20, v218 row_newbcast:12 row_mask:0xf bank_mask:0xf
    v_dot2c_f32_bf16_dpp v43, v20, v219 row_newbcast:12 row_mask:0xf bank_mask:0xf
    v_dot2c_f32_bf16_dpp v36, v20, v220 row_newbcast:13 row_mask:0xf bank_mask:0xf
    v_dot2c_f32_bf16_dpp v37, v20, v221 row_newbcast:13 row_mask:0xf bank_mask:0xf
    v_dot2c_f32_bf16_dpp v38, v20, v222 row_newbcast:13 row_mask:0xf bank_mask:0xf
    v_dot2c_f32_bf16_dpp v39, v20, v223 row_newbcast:13 row_mask:0xf bank_mask:0xf
    v_dot2c_f32_bf16_dpp v40, v20, v224 row_newbcast:13 row_mask:0xf bank_mask:0xf
    v_dot2c_f32_bf16_dpp v41, v20, v225 row_newbcast:13 row_mask:0xf bank_mask:0xf
    v_dot2c_f32_bf16_dpp v42, v20, v226 row_newbcast:13 row_mask:0xf bank_mask:0xf
    v_dot2c_f32_bf16_dpp v43, v20, v227 row_newbcast:13 row_mask:0xf bank_mask:0xf
    v_dot2c_f32_bf16_dpp v36, v20, v228 row_newbcast:14 row_mask:0xf bank_mask:0xf
    v_dot2c_f32_bf16_dpp v37, v20, v229 row_newbcast:14 row_mask:0xf bank_mask:0xf
    v_dot2c_f32_bf16_dpp v38, v20, v230 row_newbcast:14 row_mask:0xf bank_mask:0xf
    v_dot2c_f32_bf16_dpp v39, v20, v231 row_newbcast:14 row_mask:0xf bank_mask:0xf
    v_dot2c_f32_bf16_dpp v40, v20, v232 row_newbcast:14 row_mask:0xf bank_mask:0xf
    v_dot2c_f32_bf16_dpp v41, v20, v233 row_newbcast:14 row_mask:0xf bank_mask:0xf
    v_dot2c_f32_bf16_dpp v42, v20, v234 row_newbcast:14 row_mask:0xf bank_mask:0xf
    v_dot2c_f32_bf16_dpp v43, v20, v235 row_newbcast:14 row_mask:0xf bank_mask:0xf
    v_dot2c_f32_bf16_dpp v36, v20, v236 row_newbcast:15 row_mask:0xf bank_mask:0xf
    v_dot2c_f32_bf16_dpp v37, v20, v237 row_newbcast:15 row_mask:0xf bank_mask:0xf
    v_dot2c_f32_bf16_dpp v38, v20, v238 row_newbcast:15 row_mask:0xf bank_mask:0xf
    v_dot2c_f32_bf16_dpp v39, v20, v239 row_newbcast:15 row_mask:0xf bank_mask:0xf
    v_dot2c_f32_bf16_dpp v40, v20, v240 row_newbcast:15 row_mask:0xf bank_mask:0xf
    v_dot2c_f32_bf16_dpp v41, v20, v241 row_newbcast:15 row_mask:0xf bank_mask:0xf
    v_dot2c_f32_bf16_dpp v42, v20, v242 row_newbcast:15 row_mask:0xf bank_mask:0xf
    v_dot2c_f32_bf16_dpp v43, v20, v243 row_newbcast:15 row_mask:0xf bank_mask:0xf
    s_nop 1
    v_permlane32_swap_b32 v36, v40
    v_permlane32_swap_b32 v37, v41
    v_permlane32_swap_b32 v38, v42
    v_permlane32_swap_b32 v39, v43
    v_add_f32 v36, v36, v40
    v_add_f32 v37, v37, v41
    v_add_f32 v38, v38, v42
    v_add_f32 v39, v39, v43
    v_mov_b32 v40, v36
    v_mov_b32 v41, v37
    v_mov_b32 v42, v38
    v_mov_b32 v43, v39
    s_nop 0
    v_permlane16_swap_b32 v36, v40
    v_permlane16_swap_b32 v37, v41
    v_permlane16_swap_b32 v38, v42
    v_permlane16_swap_b32 v39, v43
    v_add_f32 v36, v36, v40
    v_add_f32 v37, v37, v41
    v_add_f32 v38, v38, v42
    v_add_f32 v39, v39, v43
    s_cmp_eq_u32 s9, 1
    s_cbranch_scc1 H_FIN
    v_mov_b32 v24, v36
    v_mov_b32 v25, v37
    v_mov_b32 v26, v38
    v_mov_b32 v27, v39
    s_branch H_SET_A
H_FIN:
    s_nop 0
    v_mov_b32_dpp v36, v24 quad_perm:[0,1,2,3] row_mask:0xa bank_mask:0xf
    v_mov_b32_dpp v37, v25 quad_perm:[0,1,2,3] row_mask:0xa bank_mask:0xf
    v_mov_b32_dpp v38, v26 quad_perm:[0,1,2,3] row_mask:0xa bank_mask:0xf
    v_mov_b32_dpp v39, v27 quad_perm:[0,1,2,3] row_mask:0xa bank_mask:0xf
    v_bfi_b32 v36, 1, v28, v36
    v_bfi_b32 v37, 1, v29, v37
    v_bfi_b32 v38, 1, v30, v38
    v_bfi_b32 v39, 1, v31, v39
    buffer_store_dwordx4 v[36:39], v17, s[52:55], s70 offen sc1
    s_cmp_lg_u32 s13, 1
    s_cbranch_scc1 H_END
    s_mov_b32 s12, 0
PF_69:
    s_add_u32 s10, s71, 0
    buffer_load_dwordx4 v[52:55], v9, s[52:55], s10 offen sc1
    s_add_u32 s10, s71, 32768
    buffer_load_dwordx4 v[56:59], v9, s[52:55], s10 offen sc1
    s_add_u32 s10, s71, 65536
    buffer_load_dwordx4 v[60:63], v9, s[52:55], s10 offen sc1
    s_add_u32 s10, s71, 98304
    buffer_load_dwordx4 v[64:67], v9, s[52:55], s10 offen sc1
    s_waitcnt vmcnt(3)
    v_xor_b32 v68, v52, v100
    v_xor_b32 v69, v53, v101
    v_xor_b32 v70, v54, v102
    v_xor_b32 v71, v55, v103
    v_or3_b32 v68, v68, v69, v70
    v_or_b32 v68, v68, v71
    s_waitcnt vmcnt(2)
    v_xor_b32 v72, v56, v104
    v_xor_b32 v73, v57, v105
    v_xor_b32 v74, v58, v106
    v_xor_b32 v75, v59, v107
    v_or3_b32 v72, v72, v73, v74
    v_or_b32 v72, v72, v75
    s_waitcnt vmcnt(1)
    v_xor_b32 v76, v60, v108
    v_xor_b32 v77, v61, v109
    v_xor_b32 v78, v62, v110
    v_xor_b32 v79, v63, v111
    v_or3_b32 v76, v76, v77, v78
    v_or_b32 v76, v76, v79
    s_waitcnt vmcnt(0)
    v_xor_b32 v80, v64, v112
    v_xor_b32 v81, v65, v113
    v_xor_b32 v82, v66, v114
    v_xor_b32 v83, v67, v115
    v_or3_b32 v80, v80, v81, v82
    v_or_b32 v80, v80, v83
    v_or3_b32 v2, v68, v72, v76
    v_or_b32 v2, v2, v80
    v_and_b32 v2, 1, v2
    v_cmp_ne_u32 vcc, 0, v2
    s_cbranch_vccz PFD_70
    s_add_u32 s12, s12, 1
    s_cmp_gt_u32 s12, 4194304
    s_cbranch_scc1 DONE
    s_sleep 2
    s_branch PF_69
PFD_70:
    v_and_b32 v52, -2, v52
    v_and_b32 v53, -2, v53
    v_and_b32 v54, -2, v54
    v_and_b32 v55, -2, v55
    v_and_b32 v56, -2, v56
    v_and_b32 v57, -2, v57
    v_and_b32 v58, -2, v58
    v_and_b32 v59, -2, v59
    v_and_b32 v60, -2, v60
    v_and_b32 v61, -2, v61
    v_and_b32 v62, -2, v62
    v_and_b32 v63, -2, v63
    v_and_b32 v64, -2, v64
    v_and_b32 v65, -2, v65
    v_and_b32 v66, -2, v66
    v_and_b32 v67, -2, v67
    v_add_f32 v52, v52, v56
    v_add_f32 v60, v60, v64
    v_add_f32 v53, v53, v57
    v_add_f32 v61, v61, v65
    v_add_f32 v54, v54, v58
    v_add_f32 v62, v62, v66
    v_add_f32 v55, v55, v59
    v_add_f32 v63, v63, v67
    v_add_f32 v52, v52, v60
    v_add_f32 v53, v53, v61
    v_add_f32 v54, v54, v62
    v_add_f32 v55, v55, v63
    s_nop 0
    v_add_f32_dpp v52, v52, v52 row_ror:8 row_mask:0xf bank_mask:0xf
    v_add_f32_dpp v53, v53, v53 row_ror:8 row_mask:0xf bank_mask:0xf
    v_add_f32_dpp v54, v54, v54 row_ror:8 row_mask:0xf bank_mask:0xf
    v_add_f32_dpp v55, v55, v55 row_ror:8 row_mask:0xf bank_mask:0xf
    s_nop 0
    v_permlane32_swap_b32 v52, v54
    v_permlane32_swap_b32 v53, v55
    s_nop 0
    v_add_f32 v52, v52, v54
    v_add_f32 v53, v53, v55
    v_mov_b32 v54, v52
    v_mov_b32 v55, v53
    s_nop 0
    v_permlane16_swap_b32 v52, v54
    v_permlane16_swap_b32 v53, v55
    s_nop 0
    v_add_f32 v52, v52, v54
    v_add_f32 v53, v53, v55
    v_cvt_pk_bf16_f32 v50, v52, v53
    s_mov_b32 exec_lo, 0xff
    s_mov_b32 exec_hi, 0xff
    buffer_store_dword v50, v8, s[60:63], s67 offen
    s_mov_b64 exec, -1
    s_branch H_END
H_SET_A:
    s_mov_b32 s9, 1
    s_mov_b32 s48, s24
    s_mov_b32 s49, s25
    s_mov_b32 s50, 0x400000
    s_mov_b32 s51, 0x20000
    s_lshl_b32 s43, s6, 17
    buffer_load_dwordx4 v[28:31], v17, s[52:55], s70 offen sc1 nt
    v_bfe_u32 v2, v0, 2, 1
    v_lshlrev_b32 v8, 10, v2
    v_and_b32 v2, 3, v0
    v_lshl_add_u32 v8, v2, 3, v8
    v_lshrrev_b32 v2, 5, v0
    v_lshl_add_u32 v8, v2, 2, v8
    s_lshl_b32 s67, s4, 11
    s_lshl_b32 s10, s6, 5
    s_add_u32 s67, s67, s10
    s_branch H_FIRST
H_END:
DONE:
    s_endpgm
.section .rodata,"a"
.p2align 6
.amdhsa_kernel concat_heads__mha_block_cached__gqa_block_cached__decode_kernel
  .amdhsa_next_free_vgpr 244
  .amdhsa_next_free_sgpr 80
  .amdhsa_accum_offset 244
  .amdhsa_group_segment_fixed_size 0
  .amdhsa_kernarg_size 104
  .amdhsa_user_sgpr_count 2
  .amdhsa_user_sgpr_kernarg_segment_ptr 1
  .amdhsa_system_sgpr_workgroup_id_x 1
.end_amdhsa_kernel
```
